```python
import torch

def _softmax(x, axis=-1):
    return torch.softmax(x, dim=axis)
def _gelu(x):
    return torch.nn.functional.gelu(x, approximate="tanh")
def _silu(x):
    return torch.nn.functional.silu(x)
def _sigmoid(x):
    return torch.sigmoid(x)
def _layernorm(x, axis=-1, eps=1e-5):
    m = x.mean(dim=axis, keepdim=True)
    v = x.var(dim=axis, keepdim=True, unbiased=False)
    return (x - m) / torch.sqrt(v + eps)
def _scatter_add(tgt, idx, src, axis=0):
    return tgt.clone().index_add_(axis, idx, src)
def _segment_sum(src, seg, n):
    out = torch.zeros((n,) + src.shape[1:], dtype=src.dtype)
    return out.index_add_(0, seg, src)
def _pad(x, pw):
    flat = tuple(v for pair in reversed(pw) for v in pair)
    return torch.nn.functional.pad(x, flat)

kernel_name = 'recurrent_scan__ssm_conv_s4d__dense_activation_squared_relu__prompt'

def setup_inputs():

    _w = (lambda a: (lambda t: t.to(torch.bfloat16) if t.is_floating_point() else t)(torch.as_tensor(a)))
    def _A_setup():
        Bsz, L, D, N = 1, 2048, 640, 192
        return {
            "u": _w((lambda *s: torch.randn(*s, dtype=torch.bfloat16) * 0.05)(Bsz, L, D)),
            "log_A_real": _w((lambda *s: torch.randn(*s, dtype=torch.bfloat16) * 3.2)(D, N) * 0.5),
            "A_imag": _w((lambda *s: torch.randn(*s, dtype=torch.bfloat16) * 0.05)(D, N) * 3.14),
            "C_real": _w((lambda *s: torch.randn(*s, dtype=torch.bfloat16) * 0.2)(D, N) / N ** 0.5),
            "C_imag": _w((lambda *s: torch.randn(*s, dtype=torch.bfloat16) * 0.2)(D, N) / N ** 0.5),
            "log_dt": _w((lambda *s: torch.randn(*s, dtype=torch.bfloat16) * 0.05)(D) * 0.5 - 4.0),
            "D_skip": _w((lambda *s: torch.randn(*s, dtype=torch.bfloat16) * 0.05)(D)),
        }
    _A_in = _A_setup()

    def _B_setup():
        B, S, D, F = 1, 2048, 640, 1536
        return {
            "x": _w((lambda *s: torch.randn(*s, dtype=torch.bfloat16) * 0.05)(B, S, D)),
            "w1": _w((lambda *s: torch.randn(*s, dtype=torch.bfloat16) * 0.05)(D, F)),
            "b1": _w((lambda *s: torch.randn(*s, dtype=torch.bfloat16) * 0.4)(F)),
            "w2": _w((lambda *s: torch.randn(*s, dtype=torch.bfloat16) * 0.05)(F, D)),
            "b2": _w((lambda *s: torch.randn(*s, dtype=torch.bfloat16) * 1.6)(D)),
        }
    _B_in = _B_setup()

    return {
        "A_u": _A_in["u"],
        "A_log_A_real": _A_in["log_A_real"],
        "A_A_imag": _A_in["A_imag"],
        "A_C_real": _A_in["C_real"],
        "A_C_imag": _A_in["C_imag"],
        "A_log_dt": _A_in["log_dt"],
        "A_D_skip": _A_in["D_skip"],
        "B_x": _B_in["x"],
        "B_w1": _B_in["w1"],
        "B_b1": _B_in["b1"],
        "B_w2": _B_in["w2"],
        "B_b2": _B_in["b2"],
    }

def reference(A_u, A_log_A_real, A_A_imag, A_C_real, A_C_imag, A_log_dt, A_D_skip, B_x, B_w1, B_b1, B_w2, B_b2):
    def _A_ref(u, log_A_real, A_imag, C_real, C_imag, log_dt, D_skip):
        L = u.shape[1]
        dt = torch.exp(log_dt)
        A = -torch.exp(log_A_real) + 1j * A_imag
        C = (C_real + 1j * C_imag) * dt[:, None]
        pos = (lambda x, dt: x.to(dt))(torch.arange(L), log_dt.dtype)
        P = torch.exp((A * dt[:, None])[:, :, None] * pos[None, None, :])
        K = 2.0 * torch.einsum("dn,dnl->dl", C, P).real
        L2 = 2 * L
        u_t = (lambda x, *d: x.permute(*d))(u, 0, 2, 1)
        Kf = (lambda x, *a, **k: torch.fft.rfft(x.float(), *a, **k))(K, L2)
        Uf = (lambda x, *a, **k: torch.fft.rfft(x.float(), *a, **k))(u_t, L2)
        y = (lambda x, *a, **k: torch.fft.irfft(x, *a, **k).to(torch.bfloat16))(Uf * Kf[None, :, :], L2)[:, :, :L]
        y = (lambda x, *d: x.permute(*d))(y, 0, 2, 1)
        return y + u * D_skip[None, None, :]

    def _B_ref(x, w1, b1, w2, b2):
        h = torch.einsum("bsd,df->bsf", x, w1) + b1
        zero = torch.zeros_like(h)
        r = torch.where(h > zero, h, zero)
        h = r * r
        out = torch.einsum("bsf,fd->bsd", h, w2) + b2
        return out

    x = A_u
    xn = _layernorm(x, axis=-1)
    s = _A_ref(xn, A_log_A_real, A_A_imag, A_C_real, A_C_imag, A_log_dt, A_D_skip)
    g = _silu(_B_ref(xn, B_w1, B_b1, B_w2, B_b2))
    return x + s * g
```

```asm
; @launch grid=(256,1,1) block=(256,1,1) lds=163840
.amdgcn_target "amdgcn-amd-amdhsa--gfx950"
.text
.globl recurrent_scan__ssm_conv_s4d__dense_activation_squared_relu__prompt_kernel
.p2align 8
.type recurrent_scan__ssm_conv_s4d__dense_activation_squared_relu__prompt_kernel,@function
recurrent_scan__ssm_conv_s4d__dense_activation_squared_relu__prompt_kernel:
    s_cmp_ge_u32 s2, 256
    s_cbranch_scc1 .Lend
    s_load_dwordx16 s[16:31], s[0:1], 0
    s_load_dwordx8 s[32:39], s[0:1], 64
    s_load_dwordx4 s[40:43], s[0:1], 96
    s_load_dwordx2 s[44:45], s[0:1], 112
    s_getpc_b64 s[72:73]
    s_and_b32 s11, s2, 7
    s_lshr_b32 s101, s2, 3
    s_lshl_b32 s82, s11, 5
    s_add_u32 s82, s82, s101
    v_lshrrev_b32 v4, 4, v0
    v_lshl_add_u32 v2, s82, 3, v4
    v_mul_u32_u24 v2, 1280, v2
    v_and_b32 v7, 15, v0
    v_lshl_add_u32 v2, v7, 4, v2
    v_lshrrev_b32 v3, 6, v0
    v_and_b32 v0, 63, v0
    v_readfirstlane_b32 s3, v3
    s_and_b32 s9, s101, 1
    s_lshl_b32 s8, s11, 4
    s_lshr_b32 s15, s101, 1
    s_add_u32 s8, s8, s15
    s_mul_i32 s8, s8, 5
    s_lshl_b32 s15, s9, 1
    s_add_u32 s8, s8, s15
    s_min_u32 s12, s3, 2
    s_add_u32 s12, s12, s8
    s_mul_i32 s15, s12, 384
    s_lshl_b32 s12, s12, 1
    s_and_b32 s13, s12, -4
    s_lshl_b32 s46, s12, 3
    v_mul_u32_u24 v6, 6, v0
    v_and_b32 v6, -4, v6
    v_add_u32 v6, s15, v6
    v_mov_b32 v10, 40896
    v_mov_b32 v12, 0
    v_mov_b32 v13, 0
    ds_write_b64 v10, v[12:13]
    s_cmp_ge_u32 s3, 2
    s_waitcnt lgkmcnt(0)
    s_cbranch_scc1 .Lnox
    s_nop 0
    global_load_dwordx4 v[20:23], v2, s[16:17] offset:0
    global_load_dwordx4 v[24:27], v2, s[16:17] offset:256
    global_load_dwordx4 v[28:31], v2, s[16:17] offset:512
    global_load_dwordx4 v[32:35], v2, s[16:17] offset:768
    global_load_dwordx4 v[36:39], v2, s[16:17] offset:1024
.Lnox:
    s_load_dword s47, s[26:27], s13
    s_barrier
    s_cmp_eq_u32 s3, 3
    s_cbranch_scc1 .Lnopar
    global_load_dwordx2 v[120:121], v6, s[18:19]
    global_load_dwordx2 v[122:123], v6, s[20:21]
    global_load_dwordx2 v[124:125], v6, s[22:23]
    global_load_dwordx2 v[126:127], v6, s[24:25]
.Lnopar:
    v_min_u32 v10, 2, v0
    v_mul_u32_u24 v10, 10, v10
    v_min_u32 v11, 1, v0
    v_lshlrev_b32 v11, 1, v11
    v_cmp_lt_u32 vcc, 1, v0
    s_lshr_b32 s12, s82, 7
    v_add_u32 v11, s12, v11
    v_cndmask_b32 v10, v11, 10, vcc
    v_cmp_lt_u32 vcc, 2, v0
    s_nop 1
    v_cndmask_b32 v10, v10, 11, vcc
    v_lshlrev_b32 v10, 21, v10
    v_add_u32 v10, 0x1fff80, v10
    v_mov_b32 v12, 0x80
    s_mul_i32 s12, s101, 1120
    v_lshl_add_u32 v1, v0, 5, s12
    s_cmp_eq_u32 s3, 1
    s_cbranch_scc1 .Ltlb1
    s_cmp_eq_u32 s3, 2
    s_cbranch_scc1 .Ltlb2
    s_cmp_eq_u32 s3, 3
    s_cbranch_scc1 .Ltlb3
    global_load_dword a255, v1, s[72:73]
    s_branch .Ltlbd
.Ltlb1:
    s_lshl_b32 s12, s101, 21
    s_add_u32 s12, s12, 0x1fff80
    s_mov_b64 s[68:69], s[44:45]
    s_cmp_eq_u32 s101, 12
    s_cselect_b64 s[68:69], s[34:35], s[68:69]
    s_cselect_b32 s12, 128, s12
    s_cmp_eq_u32 s101, 13
    s_cselect_b64 s[68:69], s[16:17], s[68:69]
    s_cselect_b32 s12, 0, s12
    s_cmp_eq_u32 s101, 14
    s_cselect_b64 s[68:69], s[16:17], s[68:69]
    s_cselect_b32 s12, 2097152, s12
    s_cmp_eq_u32 s101, 15
    s_cselect_b64 s[68:69], s[38:39], s[68:69]
    s_cselect_b32 s12, 128, s12
    s_cmp_eq_u32 s101, 16
    s_cselect_b64 s[68:69], s[28:29], s[68:69]
    s_cselect_b32 s12, 128, s12
    s_cmp_eq_u32 s101, 17
    s_cselect_b64 s[68:69], s[40:41], s[68:69]
    s_cselect_b32 s12, 0, s12
    s_cmp_eq_u32 s101, 18
    s_cselect_b64 s[68:69], s[40:41], s[68:69]
    s_cselect_b32 s12, 2097152, s12
    v_mov_b32 v12, s12
    s_cmp_ge_u32 s101, 19
    s_cbranch_scc1 .Ltlbd
    global_load_dword a255, v12, s[68:69]
    s_branch .Ltlbd
.Ltlb3:
    global_load_dword a255, v10, s[44:45]
    s_branch .Ltlbd
.Ltlb2:
    global_load_dword a255, v12, s[42:43]
    s_cmp_lg_u32 s2, 0
    s_cbranch_scc1 .Ltlbd
    s_memrealtime s[68:69]
    s_waitcnt lgkmcnt(0)
    s_lshl_b32 s68, s68, 1
    s_or_b32 s68, s68, 1
    v_mov_b32 v1, s68
    v_mov_b32 v2, 0
    global_store_dword v2, v1, s[42:43] sc0 sc1
.Ltlbd:
    s_mov_b32 s52, s32
    s_mov_b32 s53, s33
    s_mov_b32 s54, 1966080
    s_mov_b32 s55, 0x20000
    s_mov_b32 s56, s36
    s_mov_b32 s57, s37
    s_mov_b32 s58, 1966080
    s_mov_b32 s59, 0x20000
    s_mov_b32 s60, s44
    s_mov_b32 s61, s45
    s_mov_b32 s62, 268435456
    s_mov_b32 s63, 0x20000
    s_mov_b32 s48, s16
    s_mov_b32 s49, s17
    s_mov_b32 s50, 2621440
    s_mov_b32 s51, 0x20000
    s_mov_b32 s64, s40
    s_mov_b32 s65, s41
    s_mov_b32 s66, 2621440
    s_mov_b32 s67, 0x20000
    s_lshr_b32 s13, s11, 1
    s_and_b32 s83, s11, 1
    s_lshl_b32 s4, s13, 2
    s_and_b32 s15, s101, 3
    s_add_u32 s4, s4, s15
    s_lshl_b32 s5, s83, 3
    s_lshr_b32 s12, s101, 2
    s_add_u32 s5, s5, s12
    s_lshl_b32 s15, s15, 1
    s_and_b32 s80, s5, 0
    s_mul_i32 s80, s80, 8
    s_add_u32 s80, s15, s80
    s_lshl_b32 s6, s13, 3
    s_and_b32 s15, s101, 7
    s_add_u32 s6, s6, s15
    s_lshl_b32 s7, s83, 2
    s_lshr_b32 s15, s101, 3
    s_add_u32 s7, s7, s15
    s_mov_b32 s10, 0
    s_nop 0
    s_mul_i32 s78, s3, 8704
    s_mul_i32 s79, s3, 15360
    s_add_u32 s79, s79, 40960
    s_mul_i32 s81, s5, 192
    s_mov_b32 s70, 40960
    s_and_b32 s12, s80, 7
    s_mul_i32 s71, s12, 245760
    s_add_u32 s71, s71, s81
    s_add_u32 s74, s81, 1966080
    v_add_u32 v15, 0, v0
    v_mul_u32_u24 v2, 43691, v15
    v_lshrrev_b32 v2, 19, v2
    v_mul_u32_u24 v3, 12, v2
    v_sub_u32 v3, v15, v3
    v_mul_u32_u24 v2, 3072, v2
    v_lshl_add_u32 v241, v3, 4, v2
    v_add_u32 v15, 64, v0
    v_mul_u32_u24 v2, 43691, v15
    v_lshrrev_b32 v2, 19, v2
    v_mul_u32_u24 v3, 12, v2
    v_sub_u32 v3, v15, v3
    v_mul_u32_u24 v2, 3072, v2
    v_lshl_add_u32 v242, v3, 4, v2
    v_add_u32 v15, 128, v0
    v_mul_u32_u24 v2, 43691, v15
    v_lshrrev_b32 v2, 19, v2
    v_mul_u32_u24 v3, 12, v2
    v_sub_u32 v3, v15, v3
    v_mul_u32_u24 v2, 3072, v2
    v_lshl_add_u32 v243, v3, 4, v2
    s_nop 0
    s_lshl_b32 s11, s4, 2
    s_add_u32 s11, s11, s3
    s_mul_i32 s76, s11, 65536
    s_lshl_b32 s12, s11, 4
    s_add_u32 s12, s12, s5
    s_lshl_b32 s12, s12, 7
    s_add_u32 s89, s12, 22085632
    s_lshl_b32 s12, s11, 9
    s_add_u32 s12, s12, 22020096
    v_and_b32 v1, 3, v0
    v_lshl_add_u32 v240, v1, 7, s12
    s_lshl_b32 s11, s11, 1
    s_mul_i32 s11, s11, 64
    s_mul_i32 s12, s5, 3
    s_add_u32 s11, s11, s12
    s_lshl_b32 s11, s11, 10
    s_add_u32 s88, s11, 8388608
    s_mul_i32 s84, s7, 0
    s_add_u32 s84, s3, s84
    s_and_b32 s84, s84, 3
    s_mul_i32 s11, s3, 1048576
    s_lshl_b32 s12, s8, 4
    s_add_u32 s11, s11, s12
    s_add_u32 s85, s11, 4194304
    s_lshl_b32 s14, s6, 6
    s_lshl_b32 s12, s84, 4
    s_add_u32 s14, s14, s12
    s_lshr_b32 s13, s14, 5
    s_mul_i32 s13, s13, 64
    s_mul_i32 s12, s7, 5
    s_add_u32 s13, s13, s12
    s_lshl_b32 s13, s13, 10
    s_and_b32 s12, s14, 31
    s_lshl_b32 s12, s12, 4
    s_add_u32 s86, s13, s12
    s_mul_i32 s87, s14, 1280
    s_mul_i32 s12, s7, 160
    s_add_u32 s87, s87, s12
    s_mul_i32 s11, s7, 655360
    s_lshl_b32 s12, s6, 7
    s_add_u32 s11, s11, s12
    s_mul_i32 s12, s3, 163840
    s_add_u32 s11, s11, s12
    s_add_u32 s94, s11, 16777216
    s_add_u32 s95, s94, 65536
    s_add_u32 s96, s94, 98304
    s_add_u32 s97, s9, s3
    s_cmp_eq_u32 s3, 2
    s_cselect_b32 s97, s9, s97
    s_cselect_b32 s99, 1, 0
    s_add_u32 s98, s9, 1
    s_lshl_b32 s12, s9, 1
    s_sub_u32 s12, 2, s12
    s_cmp_eq_u32 s3, 3
    s_cselect_b32 s99, s9, s99
    s_cselect_b32 s97, s12, s97
    s_cselect_b32 s98, 0, s98
    s_add_u32 s11, s84, 1
    s_and_b32 s11, s11, 3
    s_lshl_b32 s12, s6, 2
    s_add_u32 s11, s11, s12
    s_mul_i32 s11, s11, 64
    s_mul_i32 s12, s3, 12
    s_add_u32 s11, s11, s12
    s_lshl_b32 s11, s11, 10
    s_add_u32 s90, s11, 8388608
    s_add_u32 s11, s84, 2
    s_and_b32 s11, s11, 3
    s_lshl_b32 s12, s6, 2
    s_add_u32 s11, s11, s12
    s_mul_i32 s11, s11, 64
    s_mul_i32 s12, s3, 12
    s_add_u32 s11, s11, s12
    s_lshl_b32 s11, s11, 10
    s_add_u32 s91, s11, 8388608
    s_add_u32 s11, s84, 3
    s_and_b32 s11, s11, 3
    s_lshl_b32 s12, s6, 2
    s_add_u32 s11, s11, s12
    s_mul_i32 s11, s11, 64
    s_mul_i32 s12, s3, 12
    s_add_u32 s11, s11, s12
    s_lshl_b32 s11, s11, 10
    s_add_u32 s92, s11, 8388608
    s_add_u32 s11, s84, 4
    s_and_b32 s11, s11, 3
    s_lshl_b32 s12, s6, 2
    s_add_u32 s11, s11, s12
    s_mul_i32 s11, s11, 64
    s_mul_i32 s12, s3, 12
    s_add_u32 s11, s11, s12
    s_lshl_b32 s11, s11, 10
    s_add_u32 s93, s11, 8388608
    v_add_u32 v15, 0, v0
    v_mul_u32_u24 v2, 52429, v15
    v_lshrrev_b32 v2, 19, v2
    v_mul_u32_u24 v3, 10, v2
    v_sub_u32 v3, v15, v3
    v_mul_u32_u24 v2, 1280, v2
    v_lshl_add_u32 v95, v3, 4, v2
    v_add_u32 v15, 64, v0
    v_mul_u32_u24 v2, 52429, v15
    v_lshrrev_b32 v2, 19, v2
    v_mul_u32_u24 v3, 10, v2
    v_sub_u32 v3, v15, v3
    v_mul_u32_u24 v2, 1280, v2
    v_lshl_add_u32 v96, v3, 4, v2
    v_add_u32 v15, 128, v0
    v_mul_u32_u24 v2, 52429, v15
    v_lshrrev_b32 v2, 19, v2
    v_mul_u32_u24 v3, 10, v2
    v_sub_u32 v3, v15, v3
    v_mul_u32_u24 v2, 1280, v2
    v_lshl_add_u32 v97, v3, 4, v2
    v_and_b32 v5, 31, v0
    v_lshrrev_b32 v8, 4, v0
    v_lshrrev_b32 v9, 5, v0
    v_and_b32 v13, 1, v8
    v_and_b32 v1, 3, v0
    v_lshrrev_b32 v14, 2, v0
    v_lshlrev_b32 v253, 4, v0
    v_add_u32 v252, 1024, v253
    v_lshlrev_b32 v245, 3, v9
    v_add_u32 v245, 39168, v245
    v_add_u32 v104, s14, v7
    v_mul_u32_u24 v104, 1280, v104
    s_mul_i32 s12, s7, 160
    v_lshl_add_u32 v244, v8, 3, s12
    v_add_u32 v104, v104, v244
    v_lshlrev_b32 v244, 3, v8
    v_add_u32 v244, 39424, v244
    v_lshrrev_b32 v2, 2, v7
    v_lshl_add_u32 v3, v9, 3, v2
    v_mul_u32_u24 v254, 192, v3
    v_lshl_add_u32 v254, v1, 3, v254
    v_lshl_add_u32 v254, v13, 5, v254
    v_add_u32 v254, 40960, v254
    v_add_u32 v255, 61440, v254
    v_lshl_add_u32 v3, v13, 2, v2
    v_lshl_add_u32 v3, v9, 4, v3
    v_lshlrev_b32_e64 v3, 8, v3
    v_lshl_add_u32 v3, v1, 3, v3
    v_add_u32 v100, 154624, v3
    v_mul_u32_u24 v3, 16384, v14
    v_lshl_add_u32 v105, v1, 4, v3
    v_mul_u32_u24 v3, 4352, v1
    v_lshl_add_u32 v3, v14, 4, v3
    s_lshl_b32 s12, s3, 10
    s_add_u32 s12, s12, 26368
    v_add_u32 v106, s12, v3
    v_lshlrev_b32_e64 v2, 4, v7
    v_lshl_add_u32 v247, v8, 9, v2
    s_mul_i32 s12, s3, 6144
    s_add_u32 s12, s12, 102400
    v_mul_u32_u24 v3, 160, v7
    v_lshl_add_u32 v3, v8, 3, v3
    v_add_u32 v98, s12, v3
    v_lshl_add_u32 v3, v9, 8, v2
    v_lshl_add_u32 v3, v13, 3, v3
    v_add_u32 v99, s12, v3
    v_mul_u32_u24 v3, 65536, v13
    v_add_u32 v3, v3, v2
    v_lshl_add_u32 v246, v9, 8, v3
    v_lshl_add_u32 v3, v13, 8, v2
    v_lshl_add_u32 v103, v9, 10, v3
    v_add_u32 v3, v7, v8
    v_lshlrev_b32 v3, 4, v3
    v_add_u32 v101, 26128, v3
    v_and_b32 v3, 7, v0
    v_sub_u32 v3, 8, v3
    v_lshrrev_b32 v3, 1, v3
    v_lshl_add_u32 v3, v8, 2, v3
    v_lshlrev_b32 v102, 2, v3
    v_and_b32 v2, 1, v0
    v_sub_u32 v3, 1, v2
    v_mul_u32_u24 v3, 4284, v3
    v_add_u32 v102, v102, v3
    v_bfe_u32 v3, v0, 3, 1
    v_sub_u32 v3, 1, v3
    v_mul_u32_u24 v3, 1056, v3
    v_add_u32 v102, v102, v3
    v_lshrrev_b32 v3, 3, v0
    v_mul_u32_u24 v3, 8192, v3
    v_and_b32 v2, 7, v0
    v_lshl_add_u32 v251, v2, 4, v3
    s_lshr_b32 s11, s6, 1
    s_lshl_b32 s11, s11, 2
    s_and_b32 s12, s6, 1
    s_lshl_b32 s12, s12, 1
    s_add_u32 s11, s11, s12
    s_lshl_b32 s11, s11, 4
    s_lshl_b32 s12, s3, 2
    s_add_u32 s11, s11, s12
    s_lshl_b32 s11, s11, 7
    s_add_u32 s11, s11, 22085632
    v_and_b32 v3, 1, v14
    v_lshlrev_b32 v3, 11, v3
    v_lshl_add_u32 v3, v1, 7, v3
    v_add_u32 v250, s11, v3
    v_sub_u32 v2, 31, v5
    v_lshl_add_u32 v2, v2, 4, s78
    v_sub_u32 v3, 1, v9
    v_lshl_add_u32 v248, v3, 9, v2
    v_mul_u32_u24 v3, 1056, v3
    v_add_u32 v249, v3, v2
    v_mul_u32_u24 v1, 1344, v4
    v_lshl_add_u32 v1, v7, 4, v1
    v_add_u32 v1, 26112, v1
    s_cmp_eq_u32 s3, 3
    s_cbranch_scc1 .Lw3
    s_cmp_eq_u32 s3, 2
    s_cbranch_scc1 .Lkgen
    s_waitcnt vmcnt(4)
    v_lshlrev_b32 v40, 16, v20
    v_and_b32 v41, 0xffff0000, v20
    v_lshlrev_b32 v42, 16, v21
    v_and_b32 v43, 0xffff0000, v21
    v_lshlrev_b32 v44, 16, v22
    v_and_b32 v45, 0xffff0000, v22
    v_lshlrev_b32 v46, 16, v23
    v_and_b32 v47, 0xffff0000, v23
    v_pk_add_f32 v[80:81], v[40:41], v[42:43]
    v_pk_add_f32 v[82:83], v[44:45], v[46:47]
    v_lshlrev_b32 v48, 16, v24
    v_and_b32 v49, 0xffff0000, v24
    v_pk_add_f32 v[80:81], v[80:81], v[48:49]
    v_lshlrev_b32 v50, 16, v25
    v_and_b32 v51, 0xffff0000, v25
    v_pk_add_f32 v[82:83], v[82:83], v[50:51]
    v_lshlrev_b32 v52, 16, v26
    v_and_b32 v53, 0xffff0000, v26
    v_pk_add_f32 v[80:81], v[80:81], v[52:53]
    v_lshlrev_b32 v54, 16, v27
    v_and_b32 v55, 0xffff0000, v27
    v_pk_add_f32 v[82:83], v[82:83], v[54:55]
    v_lshlrev_b32 v56, 16, v28
    v_and_b32 v57, 0xffff0000, v28
    v_pk_add_f32 v[80:81], v[80:81], v[56:57]
    v_lshlrev_b32 v58, 16, v29
    v_and_b32 v59, 0xffff0000, v29
    v_pk_add_f32 v[82:83], v[82:83], v[58:59]
    v_lshlrev_b32 v60, 16, v30
    v_and_b32 v61, 0xffff0000, v30
    v_pk_add_f32 v[80:81], v[80:81], v[60:61]
    v_lshlrev_b32 v62, 16, v31
    v_and_b32 v63, 0xffff0000, v31
    v_pk_add_f32 v[82:83], v[82:83], v[62:63]
    v_lshlrev_b32 v64, 16, v32
    v_and_b32 v65, 0xffff0000, v32
    v_pk_add_f32 v[80:81], v[80:81], v[64:65]
    v_lshlrev_b32 v66, 16, v33
    v_and_b32 v67, 0xffff0000, v33
    v_pk_add_f32 v[82:83], v[82:83], v[66:67]
    v_lshlrev_b32 v68, 16, v34
    v_and_b32 v69, 0xffff0000, v34
    v_pk_add_f32 v[80:81], v[80:81], v[68:69]
    v_lshlrev_b32 v70, 16, v35
    v_and_b32 v71, 0xffff0000, v35
    v_pk_add_f32 v[82:83], v[82:83], v[70:71]
    v_lshlrev_b32 v72, 16, v36
    v_and_b32 v73, 0xffff0000, v36
    v_pk_add_f32 v[80:81], v[80:81], v[72:73]
    v_lshlrev_b32 v74, 16, v37
    v_and_b32 v75, 0xffff0000, v37
    v_pk_add_f32 v[82:83], v[82:83], v[74:75]
    v_lshlrev_b32 v76, 16, v38
    v_and_b32 v77, 0xffff0000, v38
    v_pk_add_f32 v[80:81], v[80:81], v[76:77]
    v_lshlrev_b32 v78, 16, v39
    v_and_b32 v79, 0xffff0000, v39
    v_pk_add_f32 v[82:83], v[82:83], v[78:79]
    v_pk_add_f32 v[80:81], v[80:81], v[82:83]
    v_add_f32 v80, v80, v81
    s_nop 1
    v_add_f32_dpp v80, v80, v80 row_ror:8 row_mask:0xf bank_mask:0xf
    s_nop 1
    v_add_f32_dpp v80, v80, v80 row_ror:4 row_mask:0xf bank_mask:0xf
    s_nop 1
    v_add_f32_dpp v80, v80, v80 row_ror:2 row_mask:0xf bank_mask:0xf
    s_nop 1
    v_add_f32_dpp v80, v80, v80 row_ror:1 row_mask:0xf bank_mask:0xf
    v_mul_f32 v84, 3133983949, v80
    v_cvt_pk_bf16_f32 v80, v84, v84
    v_and_b32 v80, 0xffff0000, v80
    v_mov_b32 v81, v80
    v_sub_f32_e64 v84, v84, v80
    v_pk_add_f32 v[40:41], v[40:41], v[80:81]
    v_cvt_pk_bf16_f32 v20, v40, v41
    v_pk_mul_f32 v[82:83], v[40:41], v[40:41]
    v_pk_add_f32 v[42:43], v[42:43], v[80:81]
    v_cvt_pk_bf16_f32 v21, v42, v43
    v_pk_mul_f32 v[86:87], v[42:43], v[42:43]
    v_pk_add_f32 v[44:45], v[44:45], v[80:81]
    v_cvt_pk_bf16_f32 v22, v44, v45
    v_pk_fma_f32 v[82:83], v[44:45], v[44:45], v[82:83]
    v_pk_add_f32 v[46:47], v[46:47], v[80:81]
    v_cvt_pk_bf16_f32 v23, v46, v47
    v_pk_fma_f32 v[86:87], v[46:47], v[46:47], v[86:87]
    v_pk_add_f32 v[48:49], v[48:49], v[80:81]
    v_cvt_pk_bf16_f32 v24, v48, v49
    v_pk_fma_f32 v[82:83], v[48:49], v[48:49], v[82:83]
    v_pk_add_f32 v[50:51], v[50:51], v[80:81]
    v_cvt_pk_bf16_f32 v25, v50, v51
    v_pk_fma_f32 v[86:87], v[50:51], v[50:51], v[86:87]
    v_pk_add_f32 v[52:53], v[52:53], v[80:81]
    v_cvt_pk_bf16_f32 v26, v52, v53
    v_pk_fma_f32 v[82:83], v[52:53], v[52:53], v[82:83]
    v_pk_add_f32 v[54:55], v[54:55], v[80:81]
    v_cvt_pk_bf16_f32 v27, v54, v55
    v_pk_fma_f32 v[86:87], v[54:55], v[54:55], v[86:87]
    v_pk_add_f32 v[56:57], v[56:57], v[80:81]
    v_cvt_pk_bf16_f32 v28, v56, v57
    v_pk_fma_f32 v[82:83], v[56:57], v[56:57], v[82:83]
    v_pk_add_f32 v[58:59], v[58:59], v[80:81]
    v_cvt_pk_bf16_f32 v29, v58, v59
    v_pk_fma_f32 v[86:87], v[58:59], v[58:59], v[86:87]
    v_pk_add_f32 v[60:61], v[60:61], v[80:81]
    v_cvt_pk_bf16_f32 v30, v60, v61
    v_pk_fma_f32 v[82:83], v[60:61], v[60:61], v[82:83]
    v_pk_add_f32 v[62:63], v[62:63], v[80:81]
    v_cvt_pk_bf16_f32 v31, v62, v63
    v_pk_fma_f32 v[86:87], v[62:63], v[62:63], v[86:87]
    v_pk_add_f32 v[64:65], v[64:65], v[80:81]
    v_cvt_pk_bf16_f32 v32, v64, v65
    v_pk_fma_f32 v[82:83], v[64:65], v[64:65], v[82:83]
    v_pk_add_f32 v[66:67], v[66:67], v[80:81]
    v_cvt_pk_bf16_f32 v33, v66, v67
    v_pk_fma_f32 v[86:87], v[66:67], v[66:67], v[86:87]
    v_pk_add_f32 v[68:69], v[68:69], v[80:81]
    v_cvt_pk_bf16_f32 v34, v68, v69
    v_pk_fma_f32 v[82:83], v[68:69], v[68:69], v[82:83]
    v_pk_add_f32 v[70:71], v[70:71], v[80:81]
    v_cvt_pk_bf16_f32 v35, v70, v71
    v_pk_fma_f32 v[86:87], v[70:71], v[70:71], v[86:87]
    v_pk_add_f32 v[72:73], v[72:73], v[80:81]
    v_cvt_pk_bf16_f32 v36, v72, v73
    v_pk_fma_f32 v[82:83], v[72:73], v[72:73], v[82:83]
    v_pk_add_f32 v[74:75], v[74:75], v[80:81]
    v_cvt_pk_bf16_f32 v37, v74, v75
    v_pk_fma_f32 v[86:87], v[74:75], v[74:75], v[86:87]
    v_pk_add_f32 v[76:77], v[76:77], v[80:81]
    v_cvt_pk_bf16_f32 v38, v76, v77
    v_pk_fma_f32 v[82:83], v[76:77], v[76:77], v[82:83]
    v_pk_add_f32 v[78:79], v[78:79], v[80:81]
    v_cvt_pk_bf16_f32 v39, v78, v79
    v_pk_fma_f32 v[86:87], v[78:79], v[78:79], v[86:87]
    v_pk_add_f32 v[82:83], v[82:83], v[86:87]
    v_add_f32 v82, v82, v83
    s_nop 1
    v_add_f32_dpp v82, v82, v82 row_ror:8 row_mask:0xf bank_mask:0xf
    v_lshlrev_b32 v40, 16, v20
    v_and_b32 v41, 0xffff0000, v20
    v_add_f32_dpp v82, v82, v82 row_ror:4 row_mask:0xf bank_mask:0xf
    v_lshlrev_b32 v42, 16, v21
    v_and_b32 v43, 0xffff0000, v21
    v_add_f32_dpp v82, v82, v82 row_ror:2 row_mask:0xf bank_mask:0xf
    v_lshlrev_b32 v44, 16, v22
    v_and_b32 v45, 0xffff0000, v22
    v_add_f32_dpp v82, v82, v82 row_ror:1 row_mask:0xf bank_mask:0xf
    v_lshlrev_b32 v46, 16, v23
    v_and_b32 v47, 0xffff0000, v23
    v_mul_f32 v84, v84, v84
    v_lshlrev_b32 v48, 16, v24
    v_and_b32 v49, 0xffff0000, v24
    v_mul_f32 v82, 986500301, v82
    v_lshlrev_b32 v50, 16, v25
    v_and_b32 v51, 0xffff0000, v25
    v_sub_f32 v82, v82, v84
    v_lshlrev_b32 v52, 16, v26
    v_and_b32 v53, 0xffff0000, v26
    v_max_f32 v82, 0, v82
    v_lshlrev_b32 v54, 16, v27
    v_and_b32 v55, 0xffff0000, v27
    v_cvt_pk_bf16_f32 v82, v82, v82
    v_lshlrev_b32 v56, 16, v28
    v_and_b32 v57, 0xffff0000, v28
    v_and_b32 v82, 0xffff0000, v82
    v_lshlrev_b32 v58, 16, v29
    v_and_b32 v59, 0xffff0000, v29
    v_add_f32 v82, 925353388, v82
    v_lshlrev_b32 v60, 16, v30
    v_and_b32 v61, 0xffff0000, v30
    v_cvt_pk_bf16_f32 v82, v82, v82
    v_lshlrev_b32 v62, 16, v31
    v_and_b32 v63, 0xffff0000, v31
    v_and_b32 v82, 0xffff0000, v82
    v_lshlrev_b32 v64, 16, v32
    v_and_b32 v65, 0xffff0000, v32
    v_sqrt_f32 v82, v82
    v_lshlrev_b32 v66, 16, v33
    v_and_b32 v67, 0xffff0000, v33
    v_cvt_pk_bf16_f32 v82, v82, v82
    v_lshlrev_b32 v68, 16, v34
    v_and_b32 v69, 0xffff0000, v34
    v_and_b32 v82, 0xffff0000, v82
    v_lshlrev_b32 v70, 16, v35
    v_and_b32 v71, 0xffff0000, v35
    v_rcp_f32 v82, v82
    v_lshlrev_b32 v72, 16, v36
    v_and_b32 v73, 0xffff0000, v36
    v_lshlrev_b32 v74, 16, v37
    v_and_b32 v75, 0xffff0000, v37
    v_lshlrev_b32 v76, 16, v38
    v_and_b32 v77, 0xffff0000, v38
    v_lshlrev_b32 v78, 16, v39
    v_and_b32 v79, 0xffff0000, v39
    v_mov_b32 v83, v82
    s_lshl_b32 s12, s3, 2
    s_add_u32 s12, s12, 40896
    v_mov_b32 v2, s12
    v_mov_b32_e64 v3, 1
    v_pk_mul_f32 v[40:41], v[40:41], v[82:83]
    v_pk_mul_f32 v[42:43], v[42:43], v[82:83]
    v_pk_mul_f32 v[44:45], v[44:45], v[82:83]
    v_pk_mul_f32 v[46:47], v[46:47], v[82:83]
    v_pk_mul_f32 v[48:49], v[48:49], v[82:83]
    v_pk_mul_f32 v[50:51], v[50:51], v[82:83]
    v_pk_mul_f32 v[52:53], v[52:53], v[82:83]
    v_pk_mul_f32 v[54:55], v[54:55], v[82:83]
    v_pk_mul_f32 v[56:57], v[56:57], v[82:83]
    v_pk_mul_f32 v[58:59], v[58:59], v[82:83]
    v_pk_mul_f32 v[60:61], v[60:61], v[82:83]
    v_pk_mul_f32 v[62:63], v[62:63], v[82:83]
    v_pk_mul_f32 v[64:65], v[64:65], v[82:83]
    v_pk_mul_f32 v[66:67], v[66:67], v[82:83]
    v_pk_mul_f32 v[68:69], v[68:69], v[82:83]
    v_pk_mul_f32 v[70:71], v[70:71], v[82:83]
    v_pk_mul_f32 v[72:73], v[72:73], v[82:83]
    v_pk_mul_f32 v[74:75], v[74:75], v[82:83]
    v_pk_mul_f32 v[76:77], v[76:77], v[82:83]
    v_pk_mul_f32 v[78:79], v[78:79], v[82:83]
    v_cvt_pk_bf16_f32 v20, v40, v41
    v_cvt_pk_bf16_f32 v21, v42, v43
    v_cvt_pk_bf16_f32 v22, v44, v45
    v_cvt_pk_bf16_f32 v23, v46, v47
    v_cvt_pk_bf16_f32 v24, v48, v49
    v_cvt_pk_bf16_f32 v25, v50, v51
    v_cvt_pk_bf16_f32 v26, v52, v53
    v_cvt_pk_bf16_f32 v27, v54, v55
    v_cvt_pk_bf16_f32 v28, v56, v57
    v_cvt_pk_bf16_f32 v29, v58, v59
    v_cvt_pk_bf16_f32 v30, v60, v61
    v_cvt_pk_bf16_f32 v31, v62, v63
    v_cvt_pk_bf16_f32 v32, v64, v65
    v_cvt_pk_bf16_f32 v33, v66, v67
    v_cvt_pk_bf16_f32 v34, v68, v69
    v_cvt_pk_bf16_f32 v35, v70, v71
    v_cvt_pk_bf16_f32 v36, v72, v73
    v_cvt_pk_bf16_f32 v37, v74, v75
    v_cvt_pk_bf16_f32 v38, v76, v77
    v_cvt_pk_bf16_f32 v39, v78, v79
    ds_write_b128 v1, v[20:23] offset:0
    ds_write_b128 v1, v[24:27] offset:256
    ds_write_b128 v1, v[28:31] offset:512
    ds_write_b128 v1, v[32:35] offset:768
    ds_write_b128 v1, v[36:39] offset:1024
    ds_write_b32 v2, v3
    s_branch .Lkgen
.Lw3:
    s_mov_b32 s75, 8
.Lw1_1:
    s_waitcnt vmcnt(48)
    s_add_u32 m0, s70, 0
    s_nop 0
    buffer_load_dwordx4 v241, s[52:55], s71 offen lds
    s_add_u32 m0, s70, 1024
    s_nop 0
    buffer_load_dwordx4 v242, s[52:55], s71 offen lds
    s_add_u32 m0, s70, 2048
    s_nop 0
    buffer_load_dwordx4 v243, s[52:55], s71 offen lds
    s_add_u32 s70, s70, 3072
    s_add_u32 s71, s71, 49152
    s_cmp_eq_u32 s71, s74
    s_cselect_b32 s71, s81, s71
    s_sub_u32 s75, s75, 1
    s_cmp_lg_u32 s75, 0
    s_cbranch_scc1 .Lw1_1
    v_lshrrev_b32 v5, 3, v0
    v_and_b32 v6, 7, v0
    v_mul_u32_u24 v10, 1344, v6
    v_lshl_add_u32 v10, v5, 4, v10
    v_add_u32 v10, 26112, v10
    v_and_b32 v12, 3, v14
    v_mul_u32_u24 v12, 1344, v12
    v_and_b32 v4, 3, v0
    v_lshl_add_u32 v12, v4, 3, v12
    v_lshl_add_u32 v12, v8, 5, v12
    v_add_u32 v12, 26112, v12
    v_lshlrev_b32 v11, 10, v8
    v_and_b32 v5, 1, v5
    v_lshl_add_u32 v11, v5, 9, v11
    v_lshl_add_u32 v11, v6, 4, v11
    v_mul_u32_u24 v6, 1280, v8
    v_lshl_add_u32 v6, v7, 4, v6
    v_mov_b32 v2, 40896
    v_mov_b32 v3, 0
    s_min_u32 s12, s82, 239
    s_mul_i32 s13, s12, 52429
    s_lshr_b32 s13, s13, 18
    s_mul_i32 s14, s13, 5
    s_sub_u32 s14, s12, s14
    s_mul_i32 s15, s13, 40960
    s_lshl_b32 s12, s14, 8
    s_add_u32 s15, s15, s12
    s_mul_i32 s13, s13, 40
    s_lshl_b32 s14, s14, 3
    s_add_u32 s13, s13, s14
    s_lshl_b32 s13, s13, 10
    s_add_u32 s14, s13, 23068672
    s_lshr_b32 s12, s82, 2
    s_mul_i32 s12, s12, 65536
    s_and_b32 s13, s82, 3
    s_lshl_b32 s13, s13, 7
    s_add_u32 s12, s12, s13
    s_mul_i32 s13, s82, 16384
    s_add_u32 s13, s13, 4194304
    s_mov_b32 s11, 0
.Llnw:
    ds_read_b64 v[16:17], v2
    s_waitcnt lgkmcnt(0)
    v_and_b32 v16, v16, v17
    s_add_u32 s11, s11, 1
    v_readfirstlane_b32 s75, v16
    s_cmp_gt_u32 s11, 32000000
    s_cbranch_scc1 .Llnwx
    s_cmp_eq_u32 s75, 0
    s_cbranch_scc1 .Llnw
.Llnwx:
    ds_read_b128 v[20:23], v10 offset:0
    ds_read_b128 v[24:27], v10 offset:128
    ds_read_b128 v[28:31], v10 offset:256
    ds_read_b128 v[32:35], v10 offset:384
    ds_read_b128 v[36:39], v10 offset:512
    ds_read_b128 v[40:43], v10 offset:640
    ds_read_b128 v[44:47], v10 offset:768
    ds_read_b128 v[48:51], v10 offset:896
    ds_read_b128 v[52:55], v10 offset:1024
    ds_read_b128 v[56:59], v10 offset:1152
    global_load_dword v15, v3, s[42:43] sc0 sc1
    ds_read_b64_tr_b16 v[130:131], v12 offset:0
    ds_read_b64_tr_b16 v[132:133], v12 offset:5376
    ds_read_b64_tr_b16 v[134:135], v12 offset:128
    ds_read_b64_tr_b16 v[136:137], v12 offset:5504
    ds_read_b64_tr_b16 v[138:139], v12 offset:256
    ds_read_b64_tr_b16 v[140:141], v12 offset:5632
    ds_read_b64_tr_b16 v[142:143], v12 offset:384
    ds_read_b64_tr_b16 v[144:145], v12 offset:5760
    ds_read_b64_tr_b16 v[146:147], v12 offset:512
    ds_read_b64_tr_b16 v[148:149], v12 offset:5888
    ds_read_b64_tr_b16 v[150:151], v12 offset:640
    ds_read_b64_tr_b16 v[152:153], v12 offset:6016
    ds_read_b64_tr_b16 v[154:155], v12 offset:768
    ds_read_b64_tr_b16 v[156:157], v12 offset:6144
    ds_read_b64_tr_b16 v[158:159], v12 offset:896
    ds_read_b64_tr_b16 v[160:161], v12 offset:6272
    ds_read_b64_tr_b16 v[162:163], v12 offset:1024
    ds_read_b64_tr_b16 v[164:165], v12 offset:6400
    ds_read_b64_tr_b16 v[166:167], v12 offset:1152
    ds_read_b64_tr_b16 v[168:169], v12 offset:6528
    s_waitcnt lgkmcnt(15)
    s_nop 0
    buffer_store_dwordx4 v[20:23], v11, s[60:63], s12 offen sc0 sc1
    s_add_u32 s12, s12, 4096
    buffer_store_dwordx4 v[24:27], v11, s[60:63], s12 offen sc0 sc1
    s_add_u32 s12, s12, 4096
    buffer_store_dwordx4 v[28:31], v11, s[60:63], s12 offen sc0 sc1
    s_add_u32 s12, s12, 4096
    buffer_store_dwordx4 v[32:35], v11, s[60:63], s12 offen sc0 sc1
    s_add_u32 s12, s12, 4096
    buffer_store_dwordx4 v[36:39], v11, s[60:63], s12 offen sc0 sc1
    s_add_u32 s12, s12, 4096
    buffer_store_dwordx4 v[40:43], v11, s[60:63], s12 offen sc0 sc1
    s_add_u32 s12, s12, 4096
    buffer_store_dwordx4 v[44:47], v11, s[60:63], s12 offen sc0 sc1
    s_add_u32 s12, s12, 4096
    buffer_store_dwordx4 v[48:51], v11, s[60:63], s12 offen sc0 sc1
    s_add_u32 s12, s12, 4096
    buffer_store_dwordx4 v[52:55], v11, s[60:63], s12 offen sc0 sc1
    s_add_u32 s12, s12, 4096
    buffer_store_dwordx4 v[56:59], v11, s[60:63], s12 offen sc0 sc1
    s_mov_b32 m0, 154624
    s_nop 0
    buffer_load_dwordx4 v6, s[56:59], s15 offen lds
    s_add_u32 s15, s15, 5120
    s_mov_b32 m0, 155648
    s_nop 0
    buffer_load_dwordx4 v6, s[56:59], s15 offen lds
    s_add_u32 s15, s15, 5120
    s_mov_b32 m0, 156672
    s_nop 0
    buffer_load_dwordx4 v6, s[56:59], s15 offen lds
    s_add_u32 s15, s15, 5120
    s_mov_b32 m0, 157696
    s_nop 0
    buffer_load_dwordx4 v6, s[56:59], s15 offen lds
    s_add_u32 s15, s15, 5120
    s_mov_b32 m0, 158720
    s_nop 0
    buffer_load_dwordx4 v6, s[56:59], s15 offen lds
    s_add_u32 s15, s15, 5120
    s_mov_b32 m0, 159744
    s_nop 0
    buffer_load_dwordx4 v6, s[56:59], s15 offen lds
    s_add_u32 s15, s15, 5120
    s_mov_b32 m0, 160768
    s_nop 0
    buffer_load_dwordx4 v6, s[56:59], s15 offen lds
    s_add_u32 s15, s15, 5120
    s_mov_b32 m0, 161792
    s_nop 0
    buffer_load_dwordx4 v6, s[56:59], s15 offen lds
    s_mul_i32 s11, s7, 160
    v_add_u32 v18, s81, v253
    v_add_u32 v19, s11, v253
    s_mov_b32 exec_hi, 0
    s_mov_b32 exec_lo, 0xfff
    s_mov_b32 m0, 39168
    s_nop 0
    global_load_lds_dwordx4 v18, s[34:35]
    s_mov_b32 exec_lo, 0x3ff
    s_mov_b32 m0, 39424
    s_nop 0
    global_load_lds_dwordx4 v19, s[38:39]
    s_mov_b32 m0, 39680
    s_nop 0
    global_load_lds_dwordx4 v19, s[28:29]
    s_mov_b64 exec, -1
    s_mov_b32 s75, 2
.Lw1_2:
    s_waitcnt vmcnt(48)
    s_add_u32 m0, s70, 0
    s_nop 0
    buffer_load_dwordx4 v241, s[52:55], s71 offen lds
    s_add_u32 m0, s70, 1024
    s_nop 0
    buffer_load_dwordx4 v242, s[52:55], s71 offen lds
    s_add_u32 m0, s70, 2048
    s_nop 0
    buffer_load_dwordx4 v243, s[52:55], s71 offen lds
    s_add_u32 s70, s70, 3072
    s_add_u32 s71, s71, 49152
    s_cmp_eq_u32 s71, s74
    s_cselect_b32 s71, s81, s71
    s_sub_u32 s75, s75, 1
    s_cmp_lg_u32 s75, 0
    s_cbranch_scc1 .Lw1_2
    s_waitcnt vmcnt(27)
    v_readfirstlane_b32 s10, v15
    v_mul_u32_u24 v1, 4352, v8
    v_lshl_add_u32 v1, v7, 4, v1
    v_mov_b32 v16, 0
    v_mov_b32 v17, 0
    v_mov_b32 v18, 0
    v_mov_b32 v19, 0
    s_mov_b32 exec_hi, 0xffff
    s_waitcnt lgkmcnt(0)
    ds_write_b128 v1, v[16:19] offset:26112
    s_mov_b64 exec, -1
    s_cmp_eq_u32 s10, 0
    s_cbranch_scc1 .Lnonce_s
.Lnonce_b:
    s_lshl_b32 s12, s82, 7
    s_add_u32 s12, s12, 22020096
    v_mov_b32 v15, s10
    s_waitcnt vmcnt(17)
    s_nop 0
    buffer_store_dword v15, v3, s[60:63], s12 offen sc0 sc1
    buffer_store_dwordx4 v[130:133], v253, s[60:63], s13 offen offset:0 sc0 sc1
    buffer_store_dwordx4 v[134:137], v253, s[60:63], s13 offen offset:1024 sc0 sc1
    buffer_store_dwordx4 v[138:141], v253, s[60:63], s13 offen offset:2048 sc0 sc1
    buffer_store_dwordx4 v[142:145], v253, s[60:63], s13 offen offset:3072 sc0 sc1
    s_add_u32 s13, s13, 4096
    buffer_store_dwordx4 v[146:149], v253, s[60:63], s13 offen offset:0 sc0 sc1
    buffer_store_dwordx4 v[150:153], v253, s[60:63], s13 offen offset:1024 sc0 sc1
    buffer_store_dwordx4 v[154:157], v253, s[60:63], s13 offen offset:2048 sc0 sc1
    buffer_store_dwordx4 v[158:161], v253, s[60:63], s13 offen offset:3072 sc0 sc1
    s_add_u32 s13, s13, 4096
    buffer_store_dwordx4 v[162:165], v253, s[60:63], s13 offen offset:0 sc0 sc1
    buffer_store_dwordx4 v[166:169], v253, s[60:63], s13 offen offset:1024 sc0 sc1
    s_mov_b32 s75, 2
.Lw1_3:
    s_waitcnt vmcnt(48)
    s_add_u32 m0, s70, 0
    s_nop 0
    buffer_load_dwordx4 v241, s[52:55], s71 offen lds
    s_add_u32 m0, s70, 1024
    s_nop 0
    buffer_load_dwordx4 v242, s[52:55], s71 offen lds
    s_add_u32 m0, s70, 2048
    s_nop 0
    buffer_load_dwordx4 v243, s[52:55], s71 offen lds
    s_add_u32 s70, s70, 3072
    s_add_u32 s71, s71, 49152
    s_cmp_eq_u32 s71, s74
    s_cselect_b32 s71, s81, s71
    s_sub_u32 s75, s75, 1
    s_cmp_lg_u32 s75, 0
    s_cbranch_scc1 .Lw1_3
    s_waitcnt vmcnt(26)
    ds_read_b64_tr_b16 v[180:181], v100 offset:0
    ds_read_b64_tr_b16 v[182:183], v100 offset:2048
    ds_read_b64_tr_b16 v[184:185], v100 offset:32
    ds_read_b64_tr_b16 v[186:187], v100 offset:2080
    ds_read_b64_tr_b16 v[188:189], v100 offset:64
    ds_read_b64_tr_b16 v[190:191], v100 offset:2112
    ds_read_b64_tr_b16 v[192:193], v100 offset:96
    ds_read_b64_tr_b16 v[194:195], v100 offset:2144
    ds_read_b64_tr_b16 v[196:197], v100 offset:128
    ds_read_b64_tr_b16 v[198:199], v100 offset:2176
    ds_read_b64_tr_b16 v[200:201], v100 offset:160
    ds_read_b64_tr_b16 v[202:203], v100 offset:2208
    ds_read_b64_tr_b16 v[204:205], v100 offset:192
    ds_read_b64_tr_b16 v[206:207], v100 offset:2240
    ds_read_b64_tr_b16 v[208:209], v100 offset:224
    ds_read_b64_tr_b16 v[210:211], v100 offset:2272
    v_add_u32 v100, 4096, v253
    s_lshr_b32 s11, s82, 2
    s_lshl_b32 s11, s11, 7
    s_and_b32 s12, s82, 3
    s_lshl_b32 s12, s12, 2
    s_add_u32 s11, s11, s12
    s_add_u32 s11, s11, 22052864
    v_lshlrev_b32 v8, 7, v0
    v_add_u32 v8, 22052864, v8
    s_waitcnt lgkmcnt(14)
    buffer_store_dwordx4 v[180:183], v253, s[60:63], s14 offen offset:0 sc0 sc1
    s_waitcnt lgkmcnt(12)
    buffer_store_dwordx4 v[184:187], v253, s[60:63], s14 offen offset:1024 sc0 sc1
    s_waitcnt lgkmcnt(10)
    buffer_store_dwordx4 v[188:191], v253, s[60:63], s14 offen offset:2048 sc0 sc1
    s_waitcnt lgkmcnt(8)
    buffer_store_dwordx4 v[192:195], v253, s[60:63], s14 offen offset:3072 sc0 sc1
    s_waitcnt lgkmcnt(6)
    buffer_store_dwordx4 v[196:199], v100, s[60:63], s14 offen offset:0 sc0 sc1
    s_waitcnt lgkmcnt(4)
    buffer_store_dwordx4 v[200:203], v100, s[60:63], s14 offen offset:1024 sc0 sc1
    s_waitcnt lgkmcnt(2)
    buffer_store_dwordx4 v[204:207], v100, s[60:63], s14 offen offset:2048 sc0 sc1
    s_waitcnt lgkmcnt(0)
    buffer_store_dwordx4 v[208:211], v100, s[60:63], s14 offen offset:3072 sc0 sc1
    s_mov_b32 s75, 4
.Lw1_4:
    s_waitcnt vmcnt(48)
    s_add_u32 m0, s70, 0
    s_nop 0
    buffer_load_dwordx4 v241, s[52:55], s71 offen lds
    s_add_u32 m0, s70, 1024
    s_nop 0
    buffer_load_dwordx4 v242, s[52:55], s71 offen lds
    s_add_u32 m0, s70, 2048
    s_nop 0
    buffer_load_dwordx4 v243, s[52:55], s71 offen lds
    s_add_u32 s70, s70, 3072
    s_add_u32 s71, s71, 49152
    s_cmp_eq_u32 s71, s74
    s_cselect_b32 s71, s81, s71
    s_sub_u32 s75, s75, 1
    s_cmp_lg_u32 s75, 0
    s_cbranch_scc1 .Lw1_4
    s_waitcnt vmcnt(12)
    buffer_store_dword v15, v3, s[60:63], s11 offen sc0 sc1
    s_mov_b32 s75, 12
.Lw1_5:
    s_waitcnt vmcnt(48)
    s_add_u32 m0, s70, 0
    s_nop 0
    buffer_load_dwordx4 v241, s[52:55], s71 offen lds
    s_add_u32 m0, s70, 1024
    s_nop 0
    buffer_load_dwordx4 v242, s[52:55], s71 offen lds
    s_add_u32 m0, s70, 2048
    s_nop 0
    buffer_load_dwordx4 v243, s[52:55], s71 offen lds
    s_add_u32 s70, s70, 3072
    s_add_u32 s71, s71, 49152
    s_cmp_eq_u32 s71, s74
    s_cselect_b32 s71, s81, s71
    s_sub_u32 s75, s75, 1
    s_cmp_lg_u32 s75, 0
    s_cbranch_scc1 .Lw1_5
    v_mov_b32 v249, v8
    buffer_load_dword v1, v240, s[60:63], 0 offen sc0 sc1
    global_load_dword v2, v3, s[42:43] sc0 sc1
    s_waitcnt vmcnt(0)
    v_readfirstlane_b32 s10, v2
    s_nop 1
    v_xor_b32 v1, s10, v1
    v_cmp_eq_u32 vcc, 0, v2
    s_nop 1
    v_cndmask_b32 v1, v1, 1, vcc
    v_cmp_ne_u32 vcc, 0, v1
    s_nop 0
    s_cbranch_vccnz .Lws
    s_add_u32 s77, s80, 0
    s_and_b32 s77, s77, 7
    s_mul_i32 s77, s77, 5120
    s_add_u32 s77, s77, s76
    buffer_load_dwordx4 a[120:123], v253, s[60:63], s77 offen offset:0 sc1
    buffer_load_dwordx4 a[124:127], v253, s[60:63], s77 offen offset:1024 sc1
    buffer_load_dwordx4 a[128:131], v253, s[60:63], s77 offen offset:2048 sc1
    buffer_load_dwordx4 a[132:135], v253, s[60:63], s77 offen offset:3072 sc1
    buffer_load_dwordx4 a[136:139], v252, s[60:63], s77 offen offset:3072 sc1
    s_add_u32 s77, s80, 1
    s_and_b32 s77, s77, 7
    s_mul_i32 s77, s77, 5120
    s_add_u32 s77, s77, s76
    buffer_load_dwordx4 a[140:143], v253, s[60:63], s77 offen offset:0 sc1
    buffer_load_dwordx4 a[144:147], v253, s[60:63], s77 offen offset:1024 sc1
    buffer_load_dwordx4 a[148:151], v253, s[60:63], s77 offen offset:2048 sc1
.Lwb:
    s_branch .Lk3
.Lkgen:
    s_waitcnt vmcnt(0) lgkmcnt(0)
    s_mov_b32 m0, s78
    v_mul_u32_u24 v20, 272, v5
    v_lshl_add_u32 v20, v9, 4, v20
    v_add_u32 v20, s78, v20
    v_mov_b32 v21, 0x3f80
    s_lshr_b32 s47, s47, s46
    s_lshl_b32 s47, s47, 16
    v_mov_b32 v22, 1069066811
    v_mul_f32 v22, s47, v22
    v_exp_f32 v22, v22
    v_and_b32 v1, 1, v0
    v_lshlrev_b32 v1, 4, v1
    v_mov_b32 v3, 0
    v_cvt_pk_bf16_f32 v22, v22, v22
    v_and_b32 v22, 0xffff0000, v22
    v_alignbit_b32 v120, v121, v120, v1
    v_lshrrev_b32 v121, v1, v121
    v_lshlrev_b32 v108, 16, v120
    v_and_b32 v112, 0xffff0000, v120
    v_lshlrev_b32 v116, 16, v121
    v_alignbit_b32 v122, v123, v122, v1
    v_lshrrev_b32 v123, v1, v123
    v_lshlrev_b32 v109, 16, v122
    v_and_b32 v113, 0xffff0000, v122
    v_lshlrev_b32 v117, 16, v123
    v_alignbit_b32 v124, v125, v124, v1
    v_lshrrev_b32 v125, v1, v125
    v_lshlrev_b32 v110, 16, v124
    v_and_b32 v114, 0xffff0000, v124
    v_lshlrev_b32 v118, 16, v125
    v_alignbit_b32 v126, v127, v126, v1
    v_lshrrev_b32 v127, v1, v127
    v_lshlrev_b32 v111, 16, v126
    v_and_b32 v115, 0xffff0000, v126
    v_lshlrev_b32 v119, 16, v127
    v_add_f32 v23, v22, v22
    s_mov_b32 s15, 1042479491
    v_mul_f32 v52, 1069066811, v108
    v_mul_f32 v109, v109, v22
    v_exp_f32 v52, v52
    v_mul_f32 v53, s15, v109
    v_cvt_pk_bf16_f32 v52, v52, v52
    v_fma_f32 v54, v109, s15, -v53
    v_and_b32 v52, 0xffff0000, v52
    v_fmac_f32 v54, 836541576, v109
    v_mul_f32 v52, v52, v22
    v_mul_f32 v52, 3216550459, v52
    v_mul_f32 v69, 1090519040, v53
    v_mul_f32 v68, 1090519040, v52
    v_fract_f32 v69, v69
    v_exp_f32 v68, v68
    v_fmac_f32 v69, 1090519040, v54
    v_exp_f32 v70, v52
    v_fract_f32 v71, v53
    v_cos_f32 v58, v69
    v_add_f32 v71, v71, v54
    v_sin_f32 v59, v69
    v_mul_f32 v72, 1132462080, v52
    v_cos_f32 v56, v71
    v_mul_f32 v73, 1132462080, v53
    v_sin_f32 v57, v71
    v_fract_f32 v73, v73
    v_exp_f32 v72, v72
    v_fmac_f32 v73, 1132462080, v54
    v_pk_mul_f32 v[58:59], v[58:59], v[68:69] op_sel:[0,0] op_sel_hi:[1,0]
    v_cos_f32 v60, v73
    v_pk_mul_f32 v[56:57], v[56:57], v[70:71] op_sel:[0,0] op_sel_hi:[1,0]
    v_sin_f32 v61, v73
    v_pk_mul_f32 v[124:125], v[58:59], v[58:59] op_sel:[0,0] op_sel_hi:[1,0]
    v_pk_mul_f32 v[62:63], v[56:57], v[56:57] op_sel:[0,0] op_sel_hi:[1,0]
    v_pk_fma_f32 v[124:125], v[58:59], v[58:59], v[124:125] op_sel:[1,1,0] op_sel_hi:[0,1,1] neg_lo:[0,1,0]
    v_pk_fma_f32 v[62:63], v[56:57], v[56:57], v[62:63] op_sel:[1,1,0] op_sel_hi:[0,1,1] neg_lo:[0,1,0]
    v_mul_f32 v66, v110, v23
    v_mul_f32_e64 v67, v111, v23
    v_pk_mul_f32 v[126:127], v[124:125], v[58:59] op_sel:[0,0] op_sel_hi:[1,0]
    v_pk_mul_f32 v[128:129], v[124:125], v[124:125] op_sel:[0,0] op_sel_hi:[1,0]
    v_pk_mul_f32 v[64:65], v[62:63], v[62:63] op_sel:[0,0] op_sel_hi:[1,0]
    v_pk_fma_f32 v[126:127], v[124:125], v[58:59], v[126:127] op_sel:[1,1,0] op_sel_hi:[0,1,1] neg_lo:[0,1,0]
    v_pk_fma_f32 v[128:129], v[124:125], v[124:125], v[128:129] op_sel:[1,1,0] op_sel_hi:[0,1,1] neg_lo:[0,1,0]
    v_pk_fma_f32 v[64:65], v[62:63], v[62:63], v[64:65] op_sel:[1,1,0] op_sel_hi:[0,1,1] neg_lo:[0,1,0]
    v_pk_mul_f32 v[60:61], v[60:61], v[72:73] op_sel:[0,0] op_sel_hi:[1,0]
    v_pk_mul_f32 v[130:131], v[58:59], v[128:129] op_sel:[0,0] op_sel_hi:[1,0]
    v_pk_mul_f32 v[132:133], v[124:125], v[128:129] op_sel:[0,0] op_sel_hi:[1,0]
    v_pk_mul_f32 v[134:135], v[126:127], v[128:129] op_sel:[0,0] op_sel_hi:[1,0]
    v_pk_mul_f32 v[136:137], v[128:129], v[128:129] op_sel:[0,0] op_sel_hi:[1,0]
    v_pk_fma_f32 v[130:131], v[58:59], v[128:129], v[130:131] op_sel:[1,1,0] op_sel_hi:[0,1,1] neg_lo:[0,1,0]
    v_pk_fma_f32 v[132:133], v[124:125], v[128:129], v[132:133] op_sel:[1,1,0] op_sel_hi:[0,1,1] neg_lo:[0,1,0]
    v_pk_fma_f32 v[134:135], v[126:127], v[128:129], v[134:135] op_sel:[1,1,0] op_sel_hi:[0,1,1] neg_lo:[0,1,0]
    v_pk_fma_f32 v[136:137], v[128:129], v[128:129], v[136:137] op_sel:[1,1,0] op_sel_hi:[0,1,1] neg_lo:[0,1,0]
    v_pk_mul_f32 v[138:139], v[130:131], v[128:129] op_sel:[0,0] op_sel_hi:[1,0]
    v_pk_mul_f32 v[140:141], v[132:133], v[128:129] op_sel:[0,0] op_sel_hi:[1,0]
    v_pk_mul_f32 v[142:143], v[134:135], v[128:129] op_sel:[0,0] op_sel_hi:[1,0]
    v_pk_mul_f32 v[144:145], v[136:137], v[128:129] op_sel:[0,0] op_sel_hi:[1,0]
    v_pk_fma_f32 v[138:139], v[130:131], v[128:129], v[138:139] op_sel:[1,1,0] op_sel_hi:[0,1,1] neg_lo:[0,1,0]
    v_pk_fma_f32 v[140:141], v[132:133], v[128:129], v[140:141] op_sel:[1,1,0] op_sel_hi:[0,1,1] neg_lo:[0,1,0]
    v_pk_fma_f32 v[142:143], v[134:135], v[128:129], v[142:143] op_sel:[1,1,0] op_sel_hi:[0,1,1] neg_lo:[0,1,0]
    v_pk_fma_f32 v[144:145], v[136:137], v[128:129], v[144:145] op_sel:[1,1,0] op_sel_hi:[0,1,1] neg_lo:[0,1,0]
    v_cvt_pk_bf16_f32 v184, v58, v59
    v_cvt_pk_bf16_f32 v185, v124, v125
    v_cvt_pk_bf16_f32 v186, v126, v127
    v_cvt_pk_bf16_f32 v187, v128, v129
    v_cvt_pk_bf16_f32 v188, v130, v131
    v_cvt_pk_bf16_f32 v189, v132, v133
    v_cvt_pk_bf16_f32 v190, v134, v135
    v_cvt_pk_bf16_f32 v191, v136, v137
    ds_write_addtid_b32 v184 offset:272
    ds_write_addtid_b32 v185 offset:544
    ds_write_addtid_b32 v186 offset:816
    ds_write_addtid_b32 v187 offset:1088
    ds_write_addtid_b32 v188 offset:1360
    ds_write_addtid_b32 v189 offset:1632
    ds_write_addtid_b32 v190 offset:1904
    ds_write_addtid_b32 v191 offset:2176
    v_pk_mul_f32 v[146:147], v[138:139], v[128:129] op_sel:[0,0] op_sel_hi:[1,0]
    v_pk_mul_f32 v[148:149], v[140:141], v[128:129] op_sel:[0,0] op_sel_hi:[1,0]
    v_pk_mul_f32 v[150:151], v[142:143], v[128:129] op_sel:[0,0] op_sel_hi:[1,0]
    v_pk_mul_f32 v[152:153], v[144:145], v[128:129] op_sel:[0,0] op_sel_hi:[1,0]
    v_pk_fma_f32 v[146:147], v[138:139], v[128:129], v[146:147] op_sel:[1,1,0] op_sel_hi:[0,1,1] neg_lo:[0,1,0]
    v_pk_fma_f32 v[148:149], v[140:141], v[128:129], v[148:149] op_sel:[1,1,0] op_sel_hi:[0,1,1] neg_lo:[0,1,0]
    v_pk_fma_f32 v[150:151], v[142:143], v[128:129], v[150:151] op_sel:[1,1,0] op_sel_hi:[0,1,1] neg_lo:[0,1,0]
    v_pk_fma_f32 v[152:153], v[144:145], v[128:129], v[152:153] op_sel:[1,1,0] op_sel_hi:[0,1,1] neg_lo:[0,1,0]
    v_pk_mul_f32 v[154:155], v[146:147], v[128:129] op_sel:[0,0] op_sel_hi:[1,0]
    v_pk_mul_f32 v[156:157], v[148:149], v[128:129] op_sel:[0,0] op_sel_hi:[1,0]
    v_pk_mul_f32 v[158:159], v[150:151], v[128:129] op_sel:[0,0] op_sel_hi:[1,0]
    v_pk_mul_f32 v[160:161], v[152:153], v[128:129] op_sel:[0,0] op_sel_hi:[1,0]
    v_pk_fma_f32 v[154:155], v[146:147], v[128:129], v[154:155] op_sel:[1,1,0] op_sel_hi:[0,1,1] neg_lo:[0,1,0]
    v_pk_fma_f32 v[156:157], v[148:149], v[128:129], v[156:157] op_sel:[1,1,0] op_sel_hi:[0,1,1] neg_lo:[0,1,0]
    v_pk_fma_f32 v[158:159], v[150:151], v[128:129], v[158:159] op_sel:[1,1,0] op_sel_hi:[0,1,1] neg_lo:[0,1,0]
    v_pk_fma_f32 v[160:161], v[152:153], v[128:129], v[160:161] op_sel:[1,1,0] op_sel_hi:[0,1,1] neg_lo:[0,1,0]
    v_cvt_pk_bf16_f32 v184, v138, v139
    v_cvt_pk_bf16_f32 v185, v140, v141
    v_cvt_pk_bf16_f32 v186, v142, v143
    v_cvt_pk_bf16_f32 v187, v144, v145
    v_cvt_pk_bf16_f32 v188, v146, v147
    v_cvt_pk_bf16_f32 v189, v148, v149
    v_cvt_pk_bf16_f32 v190, v150, v151
    v_cvt_pk_bf16_f32 v191, v152, v153
    ds_write_addtid_b32 v184 offset:2448
    ds_write_addtid_b32 v185 offset:2720
    ds_write_addtid_b32 v186 offset:2992
    ds_write_addtid_b32 v187 offset:3264
    ds_write_addtid_b32 v188 offset:3536
    ds_write_addtid_b32 v189 offset:3808
    ds_write_addtid_b32 v190 offset:4080
    ds_write_addtid_b32 v191 offset:4352
    v_pk_mul_f32 v[162:163], v[154:155], v[128:129] op_sel:[0,0] op_sel_hi:[1,0]
    v_pk_mul_f32 v[164:165], v[156:157], v[128:129] op_sel:[0,0] op_sel_hi:[1,0]
    v_pk_mul_f32 v[166:167], v[158:159], v[128:129] op_sel:[0,0] op_sel_hi:[1,0]
    v_pk_mul_f32 v[168:169], v[160:161], v[128:129] op_sel:[0,0] op_sel_hi:[1,0]
    v_pk_fma_f32 v[162:163], v[154:155], v[128:129], v[162:163] op_sel:[1,1,0] op_sel_hi:[0,1,1] neg_lo:[0,1,0]
    v_pk_fma_f32 v[164:165], v[156:157], v[128:129], v[164:165] op_sel:[1,1,0] op_sel_hi:[0,1,1] neg_lo:[0,1,0]
    v_pk_fma_f32 v[166:167], v[158:159], v[128:129], v[166:167] op_sel:[1,1,0] op_sel_hi:[0,1,1] neg_lo:[0,1,0]
    v_pk_fma_f32 v[168:169], v[160:161], v[128:129], v[168:169] op_sel:[1,1,0] op_sel_hi:[0,1,1] neg_lo:[0,1,0]
    v_pk_mul_f32 v[170:171], v[162:163], v[128:129] op_sel:[0,0] op_sel_hi:[1,0]
    v_pk_mul_f32 v[172:173], v[164:165], v[128:129] op_sel:[0,0] op_sel_hi:[1,0]
    v_pk_mul_f32 v[174:175], v[166:167], v[128:129] op_sel:[0,0] op_sel_hi:[1,0]
    v_pk_mul_f32 v[176:177], v[168:169], v[128:129] op_sel:[0,0] op_sel_hi:[1,0]
    v_pk_fma_f32 v[170:171], v[162:163], v[128:129], v[170:171] op_sel:[1,1,0] op_sel_hi:[0,1,1] neg_lo:[0,1,0]
    v_pk_fma_f32 v[172:173], v[164:165], v[128:129], v[172:173] op_sel:[1,1,0] op_sel_hi:[0,1,1] neg_lo:[0,1,0]
    v_pk_fma_f32 v[174:175], v[166:167], v[128:129], v[174:175] op_sel:[1,1,0] op_sel_hi:[0,1,1] neg_lo:[0,1,0]
    v_pk_fma_f32 v[176:177], v[168:169], v[128:129], v[176:177] op_sel:[1,1,0] op_sel_hi:[0,1,1] neg_lo:[0,1,0]
    v_cvt_pk_bf16_f32 v184, v154, v155
    v_cvt_pk_bf16_f32 v185, v156, v157
    v_cvt_pk_bf16_f32 v186, v158, v159
    v_cvt_pk_bf16_f32 v187, v160, v161
    v_cvt_pk_bf16_f32 v188, v162, v163
    v_cvt_pk_bf16_f32 v189, v164, v165
    v_cvt_pk_bf16_f32 v190, v166, v167
    v_cvt_pk_bf16_f32 v191, v168, v169
    ds_write_addtid_b32 v184 offset:4624
    ds_write_addtid_b32 v185 offset:4896
    ds_write_addtid_b32 v186 offset:5168
    ds_write_addtid_b32 v187 offset:5440
    ds_write_addtid_b32 v188 offset:5712
    ds_write_addtid_b32 v189 offset:5984
    ds_write_addtid_b32 v190 offset:6256
    ds_write_addtid_b32 v191 offset:6528
    v_pk_mul_f32 v[178:179], v[170:171], v[128:129] op_sel:[0,0] op_sel_hi:[1,0]
    v_pk_mul_f32 v[180:181], v[172:173], v[128:129] op_sel:[0,0] op_sel_hi:[1,0]
    v_pk_mul_f32 v[182:183], v[174:175], v[128:129] op_sel:[0,0] op_sel_hi:[1,0]
    v_pk_fma_f32 v[178:179], v[170:171], v[128:129], v[178:179] op_sel:[1,1,0] op_sel_hi:[0,1,1] neg_lo:[0,1,0]
    v_pk_fma_f32 v[180:181], v[172:173], v[128:129], v[180:181] op_sel:[1,1,0] op_sel_hi:[0,1,1] neg_lo:[0,1,0]
    v_pk_fma_f32 v[182:183], v[174:175], v[128:129], v[182:183] op_sel:[1,1,0] op_sel_hi:[0,1,1] neg_lo:[0,1,0]
    ds_write_addtid_b32 v21
    v_cvt_pk_bf16_f32 v184, v170, v171
    v_cvt_pk_bf16_f32 v185, v172, v173
    v_cvt_pk_bf16_f32 v186, v174, v175
    v_cvt_pk_bf16_f32 v187, v176, v177
    v_cvt_pk_bf16_f32 v188, v178, v179
    v_cvt_pk_bf16_f32 v189, v180, v181
    v_cvt_pk_bf16_f32 v190, v182, v183
    ds_write_addtid_b32 v184 offset:6800
    ds_write_addtid_b32 v185 offset:7072
    ds_write_addtid_b32 v186 offset:7344
    ds_write_addtid_b32 v187 offset:7616
    ds_write_addtid_b32 v188 offset:7888
    ds_write_addtid_b32 v189 offset:8160
    ds_write_addtid_b32 v190 offset:8432
    ds_read_b128 v[192:195], v20 offset:0
    ds_read_b128 v[196:199], v20 offset:32
    ds_read_b128 v[200:203], v20 offset:64
    ds_read_b128 v[204:207], v20 offset:96
    ds_read_b128 v[208:211], v20 offset:128
    ds_read_b128 v[212:215], v20 offset:160
    ds_read_b128 v[216:219], v20 offset:192
    ds_read_b128 v[220:223], v20 offset:224
    v_pk_mul_f32 v[122:123], v[66:67], v[56:57] op_sel:[0,0] op_sel_hi:[1,0]
    v_pk_mul_f32 v[124:125], v[66:67], v[62:63] op_sel:[0,0] op_sel_hi:[1,0]
    v_pk_mul_f32 v[128:129], v[66:67], v[64:65] op_sel:[0,0] op_sel_hi:[1,0]
    v_pk_mul_f32 v[136:137], v[66:67], v[58:59] op_sel:[0,0] op_sel_hi:[1,0]
    v_pk_mul_f32 v[138:139], v[66:67], v[60:61] op_sel:[0,0] op_sel_hi:[1,0]
    v_pk_fma_f32 v[122:123], v[66:67], v[56:57], v[122:123] op_sel:[1,1,0] op_sel_hi:[0,1,1] neg_lo:[0,1,0]
    v_pk_fma_f32 v[124:125], v[66:67], v[62:63], v[124:125] op_sel:[1,1,0] op_sel_hi:[0,1,1] neg_lo:[0,1,0]
    v_pk_fma_f32 v[128:129], v[66:67], v[64:65], v[128:129] op_sel:[1,1,0] op_sel_hi:[0,1,1] neg_lo:[0,1,0]
    v_pk_fma_f32 v[136:137], v[66:67], v[58:59], v[136:137] op_sel:[1,1,0] op_sel_hi:[0,1,1] neg_lo:[0,1,0]
    v_pk_fma_f32 v[138:139], v[66:67], v[60:61], v[138:139] op_sel:[1,1,0] op_sel_hi:[0,1,1] neg_lo:[0,1,0]
    v_pk_mul_f32 v[126:127], v[124:125], v[56:57] op_sel:[0,0] op_sel_hi:[1,0]
    v_pk_mul_f32 v[130:131], v[128:129], v[56:57] op_sel:[0,0] op_sel_hi:[1,0]
    v_pk_mul_f32 v[140:141], v[138:139], v[62:63] op_sel:[0,0] op_sel_hi:[1,0]
    v_pk_mul_f32 v[148:149], v[138:139], v[60:61] op_sel:[0,0] op_sel_hi:[1,0]
    v_pk_fma_f32 v[126:127], v[124:125], v[56:57], v[126:127] op_sel:[1,1,0] op_sel_hi:[0,1,1] neg_lo:[0,1,0]
    v_pk_fma_f32 v[130:131], v[128:129], v[56:57], v[130:131] op_sel:[1,1,0] op_sel_hi:[0,1,1] neg_lo:[0,1,0]
    v_pk_fma_f32 v[140:141], v[138:139], v[62:63], v[140:141] op_sel:[1,1,0] op_sel_hi:[0,1,1] neg_lo:[0,1,0]
    v_pk_fma_f32 v[148:149], v[138:139], v[60:61], v[148:149] op_sel:[1,1,0] op_sel_hi:[0,1,1] neg_lo:[0,1,0]
    v_cvt_pk_bf16_f32 v191, v66, -v67
    v_cvt_pk_bf16_f32 v184, v122, -v123
    v_cvt_pk_bf16_f32 v185, v124, -v125
    v_cvt_pk_bf16_f32 v186, v128, -v129
    v_cvt_pk_bf16_f32 v187, v136, -v137
    v_cvt_pk_bf16_f32 v188, v138, -v139
    ds_write_addtid_b32 v191 offset:0
    ds_write_addtid_b32 v184 offset:272
    ds_write_addtid_b32 v185 offset:544
    ds_write_addtid_b32 v186 offset:2176
    ds_write_addtid_b32 v187 offset:4352
    ds_write_addtid_b32 v188 offset:1088
    ds_write_addtid_b32 v188 offset:1360
    v_pk_mul_f32 v[132:133], v[128:129], v[62:63] op_sel:[0,0] op_sel_hi:[1,0]
    v_pk_mul_f32 v[142:143], v[138:139], v[64:65] op_sel:[0,0] op_sel_hi:[1,0]
    v_pk_mul_f32 v[146:147], v[138:139], v[58:59] op_sel:[0,0] op_sel_hi:[1,0]
    v_pk_mul_f32 v[154:155], v[148:149], v[60:61] op_sel:[0,0] op_sel_hi:[1,0]
    v_pk_fma_f32 v[132:133], v[128:129], v[62:63], v[132:133] op_sel:[1,1,0] op_sel_hi:[0,1,1] neg_lo:[0,1,0]
    v_pk_fma_f32 v[142:143], v[138:139], v[64:65], v[142:143] op_sel:[1,1,0] op_sel_hi:[0,1,1] neg_lo:[0,1,0]
    v_pk_fma_f32 v[146:147], v[138:139], v[58:59], v[146:147] op_sel:[1,1,0] op_sel_hi:[0,1,1] neg_lo:[0,1,0]
    v_pk_fma_f32 v[154:155], v[148:149], v[60:61], v[154:155] op_sel:[1,1,0] op_sel_hi:[0,1,1] neg_lo:[0,1,0]
    v_pk_mul_f32 v[134:135], v[132:133], v[56:57] op_sel:[0,0] op_sel_hi:[1,0]
    v_pk_mul_f32 v[144:145], v[142:143], v[62:63] op_sel:[0,0] op_sel_hi:[1,0]
    v_pk_mul_f32 v[150:151], v[148:149], v[64:65] op_sel:[0,0] op_sel_hi:[1,0]
    v_pk_mul_f32 v[160:161], v[154:155], v[60:61] op_sel:[0,0] op_sel_hi:[1,0]
    v_pk_fma_f32 v[134:135], v[132:133], v[56:57], v[134:135] op_sel:[1,1,0] op_sel_hi:[0,1,1] neg_lo:[0,1,0]
    v_pk_fma_f32 v[144:145], v[142:143], v[62:63], v[144:145] op_sel:[1,1,0] op_sel_hi:[0,1,1] neg_lo:[0,1,0]
    v_pk_fma_f32 v[150:151], v[148:149], v[64:65], v[150:151] op_sel:[1,1,0] op_sel_hi:[0,1,1] neg_lo:[0,1,0]
    v_pk_fma_f32 v[160:161], v[154:155], v[60:61], v[160:161] op_sel:[1,1,0] op_sel_hi:[0,1,1] neg_lo:[0,1,0]
    v_cvt_pk_bf16_f32 v189, v126, -v127
    v_cvt_pk_bf16_f32 v190, v130, -v131
    v_cvt_pk_bf16_f32 v191, v140, -v141
    v_cvt_pk_bf16_f32 v184, v148, -v149
    v_cvt_pk_bf16_f32 v185, v132, -v133
    v_cvt_pk_bf16_f32 v186, v142, -v143
    v_cvt_pk_bf16_f32 v187, v146, -v147
    v_cvt_pk_bf16_f32 v188, v154, -v155
    ds_write_addtid_b32 v189 offset:816
    ds_write_addtid_b32 v190 offset:2448
    ds_write_addtid_b32 v191 offset:1632
    ds_write_addtid_b32 v184 offset:4624
    ds_write_addtid_b32 v185 offset:2720
    ds_write_addtid_b32 v186 offset:1904
    ds_write_addtid_b32 v186 offset:3264
    ds_write_addtid_b32 v186 offset:3536
    ds_write_addtid_b32 v187 offset:4080
    ds_write_addtid_b32 v187 offset:5440
    ds_write_addtid_b32 v188 offset:5712
    v_pk_mul_f32 v[152:153], v[148:149], v[58:59] op_sel:[0,0] op_sel_hi:[1,0]
    v_pk_mul_f32 v[156:157], v[154:155], v[64:65] op_sel:[0,0] op_sel_hi:[1,0]
    v_pk_mul_f32 v[158:159], v[154:155], v[58:59] op_sel:[0,0] op_sel_hi:[1,0]
    v_pk_mul_f32 v[164:165], v[160:161], v[60:61] op_sel:[0,0] op_sel_hi:[1,0]
    v_pk_fma_f32 v[152:153], v[148:149], v[58:59], v[152:153] op_sel:[1,1,0] op_sel_hi:[0,1,1] neg_lo:[0,1,0]
    v_pk_fma_f32 v[156:157], v[154:155], v[64:65], v[156:157] op_sel:[1,1,0] op_sel_hi:[0,1,1] neg_lo:[0,1,0]
    v_pk_fma_f32 v[158:159], v[154:155], v[58:59], v[158:159] op_sel:[1,1,0] op_sel_hi:[0,1,1] neg_lo:[0,1,0]
    v_pk_fma_f32 v[164:165], v[160:161], v[60:61], v[164:165] op_sel:[1,1,0] op_sel_hi:[0,1,1] neg_lo:[0,1,0]
    v_pk_mul_f32 v[162:163], v[160:161], v[58:59] op_sel:[0,0] op_sel_hi:[1,0]
    v_pk_mul_f32 v[166:167], v[164:165], v[58:59] op_sel:[0,0] op_sel_hi:[1,0]
    v_pk_mul_f32 v[168:169], v[164:165], v[60:61] op_sel:[0,0] op_sel_hi:[1,0]
    v_pk_fma_f32 v[162:163], v[160:161], v[58:59], v[162:163] op_sel:[1,1,0] op_sel_hi:[0,1,1] neg_lo:[0,1,0]
    v_pk_fma_f32 v[166:167], v[164:165], v[58:59], v[166:167] op_sel:[1,1,0] op_sel_hi:[0,1,1] neg_lo:[0,1,0]
    v_pk_fma_f32 v[168:169], v[164:165], v[60:61], v[168:169] op_sel:[1,1,0] op_sel_hi:[0,1,1] neg_lo:[0,1,0]
    v_cvt_pk_bf16_f32 v189, v134, -v135
    v_cvt_pk_bf16_f32 v190, v144, -v145
    v_cvt_pk_bf16_f32 v191, v150, -v151
    v_cvt_pk_bf16_f32 v184, v160, -v161
    v_cvt_pk_bf16_f32 v185, v152, -v153
    v_cvt_pk_bf16_f32 v186, v156, -v157
    v_cvt_pk_bf16_f32 v187, v158, -v159
    v_cvt_pk_bf16_f32 v188, v164, -v165
    ds_write_addtid_b32 v189 offset:2992
    ds_write_addtid_b32 v190 offset:3808
    ds_write_addtid_b32 v191 offset:4896
    ds_write_addtid_b32 v184 offset:6528
    ds_write_addtid_b32 v185 offset:5168
    ds_write_addtid_b32 v186 offset:5984
    ds_write_addtid_b32 v187 offset:6256
    ds_write_addtid_b32 v188 offset:7072
    v_pk_mul_f32 v[170:171], v[168:169], v[58:59] op_sel:[0,0] op_sel_hi:[1,0]
    v_pk_mul_f32 v[172:173], v[168:169], v[60:61] op_sel:[0,0] op_sel_hi:[1,0]
    v_pk_fma_f32 v[170:171], v[168:169], v[58:59], v[170:171] op_sel:[1,1,0] op_sel_hi:[0,1,1] neg_lo:[0,1,0]
    v_pk_fma_f32 v[172:173], v[168:169], v[60:61], v[172:173] op_sel:[1,1,0] op_sel_hi:[0,1,1] neg_lo:[0,1,0]
    v_pk_mul_f32 v[174:175], v[172:173], v[58:59] op_sel:[0,0] op_sel_hi:[1,0]
    v_pk_fma_f32 v[174:175], v[172:173], v[58:59], v[174:175] op_sel:[1,1,0] op_sel_hi:[0,1,1] neg_lo:[0,1,0]
    v_cvt_pk_bf16_f32 v189, v162, -v163
    v_cvt_pk_bf16_f32 v190, v166, -v167
    v_cvt_pk_bf16_f32 v191, v168, -v169
    v_cvt_pk_bf16_f32 v184, v170, -v171
    v_cvt_pk_bf16_f32 v185, v172, -v173
    v_cvt_pk_bf16_f32 v186, v174, -v175
    ds_write_addtid_b32 v189 offset:6800
    ds_write_addtid_b32 v190 offset:7344
    ds_write_addtid_b32 v191 offset:7616
    ds_write_addtid_b32 v184 offset:7888
    ds_write_addtid_b32 v185 offset:8160
    ds_write_addtid_b32 v186 offset:8432
    ds_read_b128 v[224:227], v20 offset:0
    ds_read_b128 v[228:231], v20 offset:32
    ds_read_b128 v[232:235], v20 offset:64
    ds_read_b128 v[236:239], v20 offset:96
    ds_read_b128 v[76:79], v20 offset:128
    ds_read_b128 v[80:83], v20 offset:160
    ds_read_b128 v[84:87], v20 offset:192
    ds_read_b128 v[88:91], v20 offset:224
    v_mul_f32 v52, 1069066811, v112
    v_mul_f32 v113, v113, v22
    v_exp_f32 v52, v52
    v_mul_f32 v53, s15, v113
    v_cvt_pk_bf16_f32 v52, v52, v52
    v_fma_f32 v54, v113, s15, -v53
    v_and_b32 v52, 0xffff0000, v52
    v_fmac_f32 v54, 836541576, v113
    v_mul_f32 v52, v52, v22
    v_mul_f32 v52, 3216550459, v52
    v_mul_f32 v69, 1090519040, v53
    v_mul_f32 v68, 1090519040, v52
    v_fract_f32 v69, v69
    v_exp_f32 v68, v68
    v_fmac_f32 v69, 1090519040, v54
    v_exp_f32 v70, v52
    v_fract_f32 v71, v53
    v_cos_f32 v58, v69
    v_add_f32 v71, v71, v54
    v_sin_f32 v59, v69
    v_mul_f32 v72, 1132462080, v52
    v_cos_f32 v56, v71
    v_mul_f32 v73, 1132462080, v53
    v_sin_f32 v57, v71
    v_fract_f32 v73, v73
    v_exp_f32 v72, v72
    v_fmac_f32 v73, 1132462080, v54
    v_pk_mul_f32 v[58:59], v[58:59], v[68:69] op_sel:[0,0] op_sel_hi:[1,0]
    v_cos_f32 v60, v73
    v_pk_mul_f32 v[56:57], v[56:57], v[70:71] op_sel:[0,0] op_sel_hi:[1,0]
    v_sin_f32 v61, v73
    v_pk_mul_f32 v[124:125], v[58:59], v[58:59] op_sel:[0,0] op_sel_hi:[1,0]
    v_pk_mul_f32 v[62:63], v[56:57], v[56:57] op_sel:[0,0] op_sel_hi:[1,0]
    v_pk_fma_f32 v[124:125], v[58:59], v[58:59], v[124:125] op_sel:[1,1,0] op_sel_hi:[0,1,1] neg_lo:[0,1,0]
    v_pk_fma_f32 v[62:63], v[56:57], v[56:57], v[62:63] op_sel:[1,1,0] op_sel_hi:[0,1,1] neg_lo:[0,1,0]
    v_mul_f32 v66, v114, v23
    v_mul_f32_e64 v67, v115, v23
    v_pk_mul_f32 v[126:127], v[124:125], v[58:59] op_sel:[0,0] op_sel_hi:[1,0]
    v_pk_mul_f32 v[128:129], v[124:125], v[124:125] op_sel:[0,0] op_sel_hi:[1,0]
    v_pk_mul_f32 v[64:65], v[62:63], v[62:63] op_sel:[0,0] op_sel_hi:[1,0]
    v_pk_fma_f32 v[126:127], v[124:125], v[58:59], v[126:127] op_sel:[1,1,0] op_sel_hi:[0,1,1] neg_lo:[0,1,0]
    v_pk_fma_f32 v[128:129], v[124:125], v[124:125], v[128:129] op_sel:[1,1,0] op_sel_hi:[0,1,1] neg_lo:[0,1,0]
    v_pk_fma_f32 v[64:65], v[62:63], v[62:63], v[64:65] op_sel:[1,1,0] op_sel_hi:[0,1,1] neg_lo:[0,1,0]
    v_pk_mul_f32 v[60:61], v[60:61], v[72:73] op_sel:[0,0] op_sel_hi:[1,0]
    v_pk_mul_f32 v[130:131], v[58:59], v[128:129] op_sel:[0,0] op_sel_hi:[1,0]
    v_pk_mul_f32 v[132:133], v[124:125], v[128:129] op_sel:[0,0] op_sel_hi:[1,0]
    v_pk_mul_f32 v[134:135], v[126:127], v[128:129] op_sel:[0,0] op_sel_hi:[1,0]
    v_pk_mul_f32 v[136:137], v[128:129], v[128:129] op_sel:[0,0] op_sel_hi:[1,0]
    v_pk_fma_f32 v[130:131], v[58:59], v[128:129], v[130:131] op_sel:[1,1,0] op_sel_hi:[0,1,1] neg_lo:[0,1,0]
    v_pk_fma_f32 v[132:133], v[124:125], v[128:129], v[132:133] op_sel:[1,1,0] op_sel_hi:[0,1,1] neg_lo:[0,1,0]
    v_pk_fma_f32 v[134:135], v[126:127], v[128:129], v[134:135] op_sel:[1,1,0] op_sel_hi:[0,1,1] neg_lo:[0,1,0]
    v_pk_fma_f32 v[136:137], v[128:129], v[128:129], v[136:137] op_sel:[1,1,0] op_sel_hi:[0,1,1] neg_lo:[0,1,0]
    v_pk_mul_f32 v[138:139], v[130:131], v[128:129] op_sel:[0,0] op_sel_hi:[1,0]
    v_pk_mul_f32 v[140:141], v[132:133], v[128:129] op_sel:[0,0] op_sel_hi:[1,0]
    v_pk_mul_f32 v[142:143], v[134:135], v[128:129] op_sel:[0,0] op_sel_hi:[1,0]
    v_pk_mul_f32 v[144:145], v[136:137], v[128:129] op_sel:[0,0] op_sel_hi:[1,0]
    v_pk_fma_f32 v[138:139], v[130:131], v[128:129], v[138:139] op_sel:[1,1,0] op_sel_hi:[0,1,1] neg_lo:[0,1,0]
    v_pk_fma_f32 v[140:141], v[132:133], v[128:129], v[140:141] op_sel:[1,1,0] op_sel_hi:[0,1,1] neg_lo:[0,1,0]
    v_pk_fma_f32 v[142:143], v[134:135], v[128:129], v[142:143] op_sel:[1,1,0] op_sel_hi:[0,1,1] neg_lo:[0,1,0]
    v_pk_fma_f32 v[144:145], v[136:137], v[128:129], v[144:145] op_sel:[1,1,0] op_sel_hi:[0,1,1] neg_lo:[0,1,0]
    s_waitcnt lgkmcnt(7)
    s_nop 0
    v_mfma_f32_32x32x16_bf16 v[4:19], v[224:227], v[192:195], 0
    v_cvt_pk_bf16_f32 v187, v58, v59
    v_cvt_pk_bf16_f32 v188, v124, v125
    v_cvt_pk_bf16_f32 v189, v126, v127
    v_cvt_pk_bf16_f32 v190, v128, v129
    v_cvt_pk_bf16_f32 v191, v130, v131
    v_cvt_pk_bf16_f32 v184, v132, v133
    v_cvt_pk_bf16_f32 v185, v134, v135
    v_cvt_pk_bf16_f32 v186, v136, v137
    s_waitcnt lgkmcnt(6)
    s_nop 0
    v_mfma_f32_32x32x16_bf16 v[4:19], v[228:231], v[196:199], v[4:19]
    ds_write_addtid_b32 v187 offset:272
    ds_write_addtid_b32 v188 offset:544
    ds_write_addtid_b32 v189 offset:816
    ds_write_addtid_b32 v190 offset:1088
    ds_write_addtid_b32 v191 offset:1360
    ds_write_addtid_b32 v184 offset:1632
    ds_write_addtid_b32 v185 offset:1904
    ds_write_addtid_b32 v186 offset:2176
    v_pk_mul_f32 v[146:147], v[138:139], v[128:129] op_sel:[0,0] op_sel_hi:[1,0]
    v_pk_mul_f32 v[148:149], v[140:141], v[128:129] op_sel:[0,0] op_sel_hi:[1,0]
    v_pk_mul_f32 v[150:151], v[142:143], v[128:129] op_sel:[0,0] op_sel_hi:[1,0]
    v_pk_mul_f32 v[152:153], v[144:145], v[128:129] op_sel:[0,0] op_sel_hi:[1,0]
    v_pk_fma_f32 v[146:147], v[138:139], v[128:129], v[146:147] op_sel:[1,1,0] op_sel_hi:[0,1,1] neg_lo:[0,1,0]
    v_pk_fma_f32 v[148:149], v[140:141], v[128:129], v[148:149] op_sel:[1,1,0] op_sel_hi:[0,1,1] neg_lo:[0,1,0]
    v_pk_fma_f32 v[150:151], v[142:143], v[128:129], v[150:151] op_sel:[1,1,0] op_sel_hi:[0,1,1] neg_lo:[0,1,0]
    v_pk_fma_f32 v[152:153], v[144:145], v[128:129], v[152:153] op_sel:[1,1,0] op_sel_hi:[0,1,1] neg_lo:[0,1,0]
    v_pk_mul_f32 v[154:155], v[146:147], v[128:129] op_sel:[0,0] op_sel_hi:[1,0]
    v_pk_mul_f32 v[156:157], v[148:149], v[128:129] op_sel:[0,0] op_sel_hi:[1,0]
    v_pk_mul_f32 v[158:159], v[150:151], v[128:129] op_sel:[0,0] op_sel_hi:[1,0]
    v_pk_mul_f32 v[160:161], v[152:153], v[128:129] op_sel:[0,0] op_sel_hi:[1,0]
    v_pk_fma_f32 v[154:155], v[146:147], v[128:129], v[154:155] op_sel:[1,1,0] op_sel_hi:[0,1,1] neg_lo:[0,1,0]
    v_pk_fma_f32 v[156:157], v[148:149], v[128:129], v[156:157] op_sel:[1,1,0] op_sel_hi:[0,1,1] neg_lo:[0,1,0]
    v_pk_fma_f32 v[158:159], v[150:151], v[128:129], v[158:159] op_sel:[1,1,0] op_sel_hi:[0,1,1] neg_lo:[0,1,0]
    v_pk_fma_f32 v[160:161], v[152:153], v[128:129], v[160:161] op_sel:[1,1,0] op_sel_hi:[0,1,1] neg_lo:[0,1,0]
    s_waitcnt lgkmcnt(13)
    s_nop 0
    v_mfma_f32_32x32x16_bf16 v[4:19], v[232:235], v[200:203], v[4:19]
    v_cvt_pk_bf16_f32 v187, v138, v139
    v_cvt_pk_bf16_f32 v188, v140, v141
    v_cvt_pk_bf16_f32 v189, v142, v143
    v_cvt_pk_bf16_f32 v190, v144, v145
    v_cvt_pk_bf16_f32 v191, v146, v147
    v_cvt_pk_bf16_f32 v184, v148, v149
    v_cvt_pk_bf16_f32 v185, v150, v151
    v_cvt_pk_bf16_f32 v186, v152, v153
    s_waitcnt lgkmcnt(12)
    s_nop 0
    v_mfma_f32_32x32x16_bf16 v[4:19], v[236:239], v[204:207], v[4:19]
    ds_write_addtid_b32 v187 offset:2448
    ds_write_addtid_b32 v188 offset:2720
    ds_write_addtid_b32 v189 offset:2992
    ds_write_addtid_b32 v190 offset:3264
    ds_write_addtid_b32 v191 offset:3536
    ds_write_addtid_b32 v184 offset:3808
    ds_write_addtid_b32 v185 offset:4080
    ds_write_addtid_b32 v186 offset:4352
    v_pk_mul_f32 v[162:163], v[154:155], v[128:129] op_sel:[0,0] op_sel_hi:[1,0]
    v_pk_mul_f32 v[164:165], v[156:157], v[128:129] op_sel:[0,0] op_sel_hi:[1,0]
    v_pk_mul_f32 v[166:167], v[158:159], v[128:129] op_sel:[0,0] op_sel_hi:[1,0]
    v_pk_mul_f32 v[168:169], v[160:161], v[128:129] op_sel:[0,0] op_sel_hi:[1,0]
    v_pk_fma_f32 v[162:163], v[154:155], v[128:129], v[162:163] op_sel:[1,1,0] op_sel_hi:[0,1,1] neg_lo:[0,1,0]
    v_pk_fma_f32 v[164:165], v[156:157], v[128:129], v[164:165] op_sel:[1,1,0] op_sel_hi:[0,1,1] neg_lo:[0,1,0]
    v_pk_fma_f32 v[166:167], v[158:159], v[128:129], v[166:167] op_sel:[1,1,0] op_sel_hi:[0,1,1] neg_lo:[0,1,0]
    v_pk_fma_f32 v[168:169], v[160:161], v[128:129], v[168:169] op_sel:[1,1,0] op_sel_hi:[0,1,1] neg_lo:[0,1,0]
    v_pk_mul_f32 v[170:171], v[162:163], v[128:129] op_sel:[0,0] op_sel_hi:[1,0]
    v_pk_mul_f32 v[172:173], v[164:165], v[128:129] op_sel:[0,0] op_sel_hi:[1,0]
    v_pk_mul_f32 v[174:175], v[166:167], v[128:129] op_sel:[0,0] op_sel_hi:[1,0]
    v_pk_mul_f32 v[176:177], v[168:169], v[128:129] op_sel:[0,0] op_sel_hi:[1,0]
    v_pk_fma_f32 v[170:171], v[162:163], v[128:129], v[170:171] op_sel:[1,1,0] op_sel_hi:[0,1,1] neg_lo:[0,1,0]
    v_pk_fma_f32 v[172:173], v[164:165], v[128:129], v[172:173] op_sel:[1,1,0] op_sel_hi:[0,1,1] neg_lo:[0,1,0]
    v_pk_fma_f32 v[174:175], v[166:167], v[128:129], v[174:175] op_sel:[1,1,0] op_sel_hi:[0,1,1] neg_lo:[0,1,0]
    v_pk_fma_f32 v[176:177], v[168:169], v[128:129], v[176:177] op_sel:[1,1,0] op_sel_hi:[0,1,1] neg_lo:[0,1,0]
    s_waitcnt lgkmcnt(15)
    s_nop 0
    v_mfma_f32_32x32x16_bf16 v[4:19], v[76:79], v[208:211], v[4:19]
    v_cvt_pk_bf16_f32 v187, v154, v155
    v_cvt_pk_bf16_f32 v188, v156, v157
    v_cvt_pk_bf16_f32 v189, v158, v159
    v_cvt_pk_bf16_f32 v190, v160, v161
    v_cvt_pk_bf16_f32 v191, v162, v163
    v_cvt_pk_bf16_f32 v184, v164, v165
    v_cvt_pk_bf16_f32 v185, v166, v167
    v_cvt_pk_bf16_f32 v186, v168, v169
    v_mfma_f32_32x32x16_bf16 v[4:19], v[80:83], v[212:215], v[4:19]
    ds_write_addtid_b32 v187 offset:4624
    ds_write_addtid_b32 v188 offset:4896
    ds_write_addtid_b32 v189 offset:5168
    ds_write_addtid_b32 v190 offset:5440
    ds_write_addtid_b32 v191 offset:5712
    ds_write_addtid_b32 v184 offset:5984
    ds_write_addtid_b32 v185 offset:6256
    ds_write_addtid_b32 v186 offset:6528
    v_pk_mul_f32 v[178:179], v[170:171], v[128:129] op_sel:[0,0] op_sel_hi:[1,0]
    v_pk_mul_f32 v[180:181], v[172:173], v[128:129] op_sel:[0,0] op_sel_hi:[1,0]
    v_pk_mul_f32 v[182:183], v[174:175], v[128:129] op_sel:[0,0] op_sel_hi:[1,0]
    v_pk_fma_f32 v[178:179], v[170:171], v[128:129], v[178:179] op_sel:[1,1,0] op_sel_hi:[0,1,1] neg_lo:[0,1,0]
    v_pk_fma_f32 v[180:181], v[172:173], v[128:129], v[180:181] op_sel:[1,1,0] op_sel_hi:[0,1,1] neg_lo:[0,1,0]
    v_pk_fma_f32 v[182:183], v[174:175], v[128:129], v[182:183] op_sel:[1,1,0] op_sel_hi:[0,1,1] neg_lo:[0,1,0]
    ds_write_addtid_b32 v21
    v_mfma_f32_32x32x16_bf16 v[4:19], v[84:87], v[216:219], v[4:19]
    v_cvt_pk_bf16_f32 v187, v170, v171
    v_cvt_pk_bf16_f32 v188, v172, v173
    v_cvt_pk_bf16_f32 v189, v174, v175
    v_cvt_pk_bf16_f32 v190, v176, v177
    v_cvt_pk_bf16_f32 v191, v178, v179
    v_cvt_pk_bf16_f32 v184, v180, v181
    v_cvt_pk_bf16_f32 v185, v182, v183
    v_mfma_f32_32x32x16_bf16 v[4:19], v[88:91], v[220:223], v[4:19]
    ds_write_addtid_b32 v187 offset:6800
    ds_write_addtid_b32 v188 offset:7072
    ds_write_addtid_b32 v189 offset:7344
    ds_write_addtid_b32 v190 offset:7616
    ds_write_addtid_b32 v191 offset:7888
    ds_write_addtid_b32 v184 offset:8160
    ds_write_addtid_b32 v185 offset:8432
    ds_read_b128 v[192:195], v20 offset:0
    ds_read_b128 v[196:199], v20 offset:32
    ds_read_b128 v[200:203], v20 offset:64
    ds_read_b128 v[204:207], v20 offset:96
    ds_read_b128 v[208:211], v20 offset:128
    ds_read_b128 v[212:215], v20 offset:160
    ds_read_b128 v[216:219], v20 offset:192
    ds_read_b128 v[220:223], v20 offset:224
    v_pk_mul_f32 v[122:123], v[66:67], v[56:57] op_sel:[0,0] op_sel_hi:[1,0]
    v_pk_mul_f32 v[124:125], v[66:67], v[62:63] op_sel:[0,0] op_sel_hi:[1,0]
    v_pk_mul_f32 v[128:129], v[66:67], v[64:65] op_sel:[0,0] op_sel_hi:[1,0]
    v_pk_mul_f32 v[136:137], v[66:67], v[58:59] op_sel:[0,0] op_sel_hi:[1,0]
    v_pk_mul_f32 v[138:139], v[66:67], v[60:61] op_sel:[0,0] op_sel_hi:[1,0]
    v_pk_fma_f32 v[122:123], v[66:67], v[56:57], v[122:123] op_sel:[1,1,0] op_sel_hi:[0,1,1] neg_lo:[0,1,0]
    v_pk_fma_f32 v[124:125], v[66:67], v[62:63], v[124:125] op_sel:[1,1,0] op_sel_hi:[0,1,1] neg_lo:[0,1,0]
    v_pk_fma_f32 v[128:129], v[66:67], v[64:65], v[128:129] op_sel:[1,1,0] op_sel_hi:[0,1,1] neg_lo:[0,1,0]
    v_pk_fma_f32 v[136:137], v[66:67], v[58:59], v[136:137] op_sel:[1,1,0] op_sel_hi:[0,1,1] neg_lo:[0,1,0]
    v_pk_fma_f32 v[138:139], v[66:67], v[60:61], v[138:139] op_sel:[1,1,0] op_sel_hi:[0,1,1] neg_lo:[0,1,0]
    v_pk_mul_f32 v[126:127], v[124:125], v[56:57] op_sel:[0,0] op_sel_hi:[1,0]
    v_pk_mul_f32 v[130:131], v[128:129], v[56:57] op_sel:[0,0] op_sel_hi:[1,0]
    v_pk_mul_f32 v[140:141], v[138:139], v[62:63] op_sel:[0,0] op_sel_hi:[1,0]
    v_pk_mul_f32 v[148:149], v[138:139], v[60:61] op_sel:[0,0] op_sel_hi:[1,0]
    v_pk_fma_f32 v[126:127], v[124:125], v[56:57], v[126:127] op_sel:[1,1,0] op_sel_hi:[0,1,1] neg_lo:[0,1,0]
    v_pk_fma_f32 v[130:131], v[128:129], v[56:57], v[130:131] op_sel:[1,1,0] op_sel_hi:[0,1,1] neg_lo:[0,1,0]
    v_pk_fma_f32 v[140:141], v[138:139], v[62:63], v[140:141] op_sel:[1,1,0] op_sel_hi:[0,1,1] neg_lo:[0,1,0]
    v_pk_fma_f32 v[148:149], v[138:139], v[60:61], v[148:149] op_sel:[1,1,0] op_sel_hi:[0,1,1] neg_lo:[0,1,0]
    v_cvt_pk_bf16_f32 v186, v66, -v67
    v_cvt_pk_bf16_f32 v187, v122, -v123
    v_cvt_pk_bf16_f32 v188, v124, -v125
    v_cvt_pk_bf16_f32 v189, v128, -v129
    v_cvt_pk_bf16_f32 v190, v136, -v137
    v_cvt_pk_bf16_f32 v191, v138, -v139
    ds_write_addtid_b32 v186 offset:0
    ds_write_addtid_b32 v187 offset:272
    ds_write_addtid_b32 v188 offset:544
    ds_write_addtid_b32 v189 offset:2176
    ds_write_addtid_b32 v190 offset:4352
    ds_write_addtid_b32 v191 offset:1088
    ds_write_addtid_b32 v191 offset:1360
    v_pk_mul_f32 v[132:133], v[128:129], v[62:63] op_sel:[0,0] op_sel_hi:[1,0]
    v_pk_mul_f32 v[142:143], v[138:139], v[64:65] op_sel:[0,0] op_sel_hi:[1,0]
    v_pk_mul_f32 v[146:147], v[138:139], v[58:59] op_sel:[0,0] op_sel_hi:[1,0]
    v_pk_mul_f32 v[154:155], v[148:149], v[60:61] op_sel:[0,0] op_sel_hi:[1,0]
    v_pk_fma_f32 v[132:133], v[128:129], v[62:63], v[132:133] op_sel:[1,1,0] op_sel_hi:[0,1,1] neg_lo:[0,1,0]
    v_pk_fma_f32 v[142:143], v[138:139], v[64:65], v[142:143] op_sel:[1,1,0] op_sel_hi:[0,1,1] neg_lo:[0,1,0]
    v_pk_fma_f32 v[146:147], v[138:139], v[58:59], v[146:147] op_sel:[1,1,0] op_sel_hi:[0,1,1] neg_lo:[0,1,0]
    v_pk_fma_f32 v[154:155], v[148:149], v[60:61], v[154:155] op_sel:[1,1,0] op_sel_hi:[0,1,1] neg_lo:[0,1,0]
    v_pk_mul_f32 v[134:135], v[132:133], v[56:57] op_sel:[0,0] op_sel_hi:[1,0]
    v_pk_mul_f32 v[144:145], v[142:143], v[62:63] op_sel:[0,0] op_sel_hi:[1,0]
    v_pk_mul_f32 v[150:151], v[148:149], v[64:65] op_sel:[0,0] op_sel_hi:[1,0]
    v_pk_mul_f32 v[160:161], v[154:155], v[60:61] op_sel:[0,0] op_sel_hi:[1,0]
    v_pk_fma_f32 v[134:135], v[132:133], v[56:57], v[134:135] op_sel:[1,1,0] op_sel_hi:[0,1,1] neg_lo:[0,1,0]
    v_pk_fma_f32 v[144:145], v[142:143], v[62:63], v[144:145] op_sel:[1,1,0] op_sel_hi:[0,1,1] neg_lo:[0,1,0]
    v_pk_fma_f32 v[150:151], v[148:149], v[64:65], v[150:151] op_sel:[1,1,0] op_sel_hi:[0,1,1] neg_lo:[0,1,0]
    v_pk_fma_f32 v[160:161], v[154:155], v[60:61], v[160:161] op_sel:[1,1,0] op_sel_hi:[0,1,1] neg_lo:[0,1,0]
    v_cvt_pk_bf16_f32 v184, v126, -v127
    v_cvt_pk_bf16_f32 v185, v130, -v131
    v_cvt_pk_bf16_f32 v186, v140, -v141
    v_cvt_pk_bf16_f32 v187, v148, -v149
    v_cvt_pk_bf16_f32 v188, v132, -v133
    v_cvt_pk_bf16_f32 v189, v142, -v143
    v_cvt_pk_bf16_f32 v190, v146, -v147
    v_cvt_pk_bf16_f32 v191, v154, -v155
    ds_write_addtid_b32 v184 offset:816
    ds_write_addtid_b32 v185 offset:2448
    ds_write_addtid_b32 v186 offset:1632
    ds_write_addtid_b32 v187 offset:4624
    ds_write_addtid_b32 v188 offset:2720
    ds_write_addtid_b32 v189 offset:1904
    ds_write_addtid_b32 v189 offset:3264
    ds_write_addtid_b32 v189 offset:3536
    ds_write_addtid_b32 v190 offset:4080
    ds_write_addtid_b32 v190 offset:5440
    ds_write_addtid_b32 v191 offset:5712
    v_pk_mul_f32 v[152:153], v[148:149], v[58:59] op_sel:[0,0] op_sel_hi:[1,0]
    v_pk_mul_f32 v[156:157], v[154:155], v[64:65] op_sel:[0,0] op_sel_hi:[1,0]
    v_pk_mul_f32 v[158:159], v[154:155], v[58:59] op_sel:[0,0] op_sel_hi:[1,0]
    v_pk_mul_f32 v[164:165], v[160:161], v[60:61] op_sel:[0,0] op_sel_hi:[1,0]
    v_pk_fma_f32 v[152:153], v[148:149], v[58:59], v[152:153] op_sel:[1,1,0] op_sel_hi:[0,1,1] neg_lo:[0,1,0]
    v_pk_fma_f32 v[156:157], v[154:155], v[64:65], v[156:157] op_sel:[1,1,0] op_sel_hi:[0,1,1] neg_lo:[0,1,0]
    v_pk_fma_f32 v[158:159], v[154:155], v[58:59], v[158:159] op_sel:[1,1,0] op_sel_hi:[0,1,1] neg_lo:[0,1,0]
    v_pk_fma_f32 v[164:165], v[160:161], v[60:61], v[164:165] op_sel:[1,1,0] op_sel_hi:[0,1,1] neg_lo:[0,1,0]
    v_pk_mul_f32 v[162:163], v[160:161], v[58:59] op_sel:[0,0] op_sel_hi:[1,0]
    v_pk_mul_f32 v[166:167], v[164:165], v[58:59] op_sel:[0,0] op_sel_hi:[1,0]
    v_pk_mul_f32 v[168:169], v[164:165], v[60:61] op_sel:[0,0] op_sel_hi:[1,0]
    v_pk_fma_f32 v[162:163], v[160:161], v[58:59], v[162:163] op_sel:[1,1,0] op_sel_hi:[0,1,1] neg_lo:[0,1,0]
    v_pk_fma_f32 v[166:167], v[164:165], v[58:59], v[166:167] op_sel:[1,1,0] op_sel_hi:[0,1,1] neg_lo:[0,1,0]
    v_pk_fma_f32 v[168:169], v[164:165], v[60:61], v[168:169] op_sel:[1,1,0] op_sel_hi:[0,1,1] neg_lo:[0,1,0]
    v_cvt_pk_bf16_f32 v184, v134, -v135
    v_cvt_pk_bf16_f32 v185, v144, -v145
    v_cvt_pk_bf16_f32 v186, v150, -v151
    v_cvt_pk_bf16_f32 v187, v160, -v161
    v_cvt_pk_bf16_f32 v188, v152, -v153
    v_cvt_pk_bf16_f32 v189, v156, -v157
    v_cvt_pk_bf16_f32 v190, v158, -v159
    v_cvt_pk_bf16_f32 v191, v164, -v165
    ds_write_addtid_b32 v184 offset:2992
    ds_write_addtid_b32 v185 offset:3808
    ds_write_addtid_b32 v186 offset:4896
    ds_write_addtid_b32 v187 offset:6528
    ds_write_addtid_b32 v188 offset:5168
    ds_write_addtid_b32 v189 offset:5984
    ds_write_addtid_b32 v190 offset:6256
    ds_write_addtid_b32 v191 offset:7072
    v_pk_mul_f32 v[170:171], v[168:169], v[58:59] op_sel:[0,0] op_sel_hi:[1,0]
    v_pk_mul_f32 v[172:173], v[168:169], v[60:61] op_sel:[0,0] op_sel_hi:[1,0]
    v_pk_fma_f32 v[170:171], v[168:169], v[58:59], v[170:171] op_sel:[1,1,0] op_sel_hi:[0,1,1] neg_lo:[0,1,0]
    v_pk_fma_f32 v[172:173], v[168:169], v[60:61], v[172:173] op_sel:[1,1,0] op_sel_hi:[0,1,1] neg_lo:[0,1,0]
    v_pk_mul_f32 v[174:175], v[172:173], v[58:59] op_sel:[0,0] op_sel_hi:[1,0]
    v_pk_fma_f32 v[174:175], v[172:173], v[58:59], v[174:175] op_sel:[1,1,0] op_sel_hi:[0,1,1] neg_lo:[0,1,0]
    v_cvt_pk_bf16_f32 v184, v162, -v163
    v_cvt_pk_bf16_f32 v185, v166, -v167
    v_cvt_pk_bf16_f32 v186, v168, -v169
    v_cvt_pk_bf16_f32 v187, v170, -v171
    v_cvt_pk_bf16_f32 v188, v172, -v173
    v_cvt_pk_bf16_f32 v189, v174, -v175
    ds_write_addtid_b32 v184 offset:6800
    ds_write_addtid_b32 v185 offset:7344
    ds_write_addtid_b32 v186 offset:7616
    ds_write_addtid_b32 v187 offset:7888
    ds_write_addtid_b32 v188 offset:8160
    ds_write_addtid_b32 v189 offset:8432
    ds_read_b128 v[224:227], v20 offset:0
    ds_read_b128 v[228:231], v20 offset:32
    ds_read_b128 v[232:235], v20 offset:64
    ds_read_b128 v[236:239], v20 offset:96
    ds_read_b128 v[76:79], v20 offset:128
    ds_read_b128 v[80:83], v20 offset:160
    ds_read_b128 v[84:87], v20 offset:192
    ds_read_b128 v[88:91], v20 offset:224
    v_mul_f32 v52, 1069066811, v116
    v_mul_f32 v117, v117, v22
    v_exp_f32 v52, v52
    v_mul_f32 v53, s15, v117
    v_cvt_pk_bf16_f32 v52, v52, v52
    v_fma_f32 v54, v117, s15, -v53
    v_and_b32 v52, 0xffff0000, v52
    v_fmac_f32 v54, 836541576, v117
    v_mul_f32 v52, v52, v22
    v_mul_f32 v52, 3216550459, v52
    v_mul_f32 v69, 1090519040, v53
    v_mul_f32 v68, 1090519040, v52
    v_fract_f32 v69, v69
    v_exp_f32 v68, v68
    v_fmac_f32 v69, 1090519040, v54
    v_exp_f32 v70, v52
    v_fract_f32 v71, v53
    v_cos_f32 v58, v69
    v_add_f32 v71, v71, v54
    v_sin_f32 v59, v69
    v_mul_f32 v72, 1132462080, v52
    v_cos_f32 v56, v71
    v_mul_f32 v73, 1132462080, v53
    v_sin_f32 v57, v71
    v_fract_f32 v73, v73
    v_exp_f32 v72, v72
    v_fmac_f32 v73, 1132462080, v54
    v_pk_mul_f32 v[58:59], v[58:59], v[68:69] op_sel:[0,0] op_sel_hi:[1,0]
    v_cos_f32 v60, v73
    v_pk_mul_f32 v[56:57], v[56:57], v[70:71] op_sel:[0,0] op_sel_hi:[1,0]
    v_sin_f32 v61, v73
    v_pk_mul_f32 v[124:125], v[58:59], v[58:59] op_sel:[0,0] op_sel_hi:[1,0]
    v_pk_mul_f32 v[62:63], v[56:57], v[56:57] op_sel:[0,0] op_sel_hi:[1,0]
    v_pk_fma_f32 v[124:125], v[58:59], v[58:59], v[124:125] op_sel:[1,1,0] op_sel_hi:[0,1,1] neg_lo:[0,1,0]
    v_pk_fma_f32 v[62:63], v[56:57], v[56:57], v[62:63] op_sel:[1,1,0] op_sel_hi:[0,1,1] neg_lo:[0,1,0]
    v_mul_f32 v66, v118, v23
    v_mul_f32_e64 v67, v119, v23
    v_pk_mul_f32 v[126:127], v[124:125], v[58:59] op_sel:[0,0] op_sel_hi:[1,0]
    v_pk_mul_f32 v[128:129], v[124:125], v[124:125] op_sel:[0,0] op_sel_hi:[1,0]
    v_pk_mul_f32 v[64:65], v[62:63], v[62:63] op_sel:[0,0] op_sel_hi:[1,0]
    v_pk_fma_f32 v[126:127], v[124:125], v[58:59], v[126:127] op_sel:[1,1,0] op_sel_hi:[0,1,1] neg_lo:[0,1,0]
    v_pk_fma_f32 v[128:129], v[124:125], v[124:125], v[128:129] op_sel:[1,1,0] op_sel_hi:[0,1,1] neg_lo:[0,1,0]
    v_pk_fma_f32 v[64:65], v[62:63], v[62:63], v[64:65] op_sel:[1,1,0] op_sel_hi:[0,1,1] neg_lo:[0,1,0]
    v_pk_mul_f32 v[60:61], v[60:61], v[72:73] op_sel:[0,0] op_sel_hi:[1,0]
    v_pk_mul_f32 v[130:131], v[58:59], v[128:129] op_sel:[0,0] op_sel_hi:[1,0]
    v_pk_mul_f32 v[132:133], v[124:125], v[128:129] op_sel:[0,0] op_sel_hi:[1,0]
    v_pk_mul_f32 v[134:135], v[126:127], v[128:129] op_sel:[0,0] op_sel_hi:[1,0]
    v_pk_mul_f32 v[136:137], v[128:129], v[128:129] op_sel:[0,0] op_sel_hi:[1,0]
    v_pk_fma_f32 v[130:131], v[58:59], v[128:129], v[130:131] op_sel:[1,1,0] op_sel_hi:[0,1,1] neg_lo:[0,1,0]
    v_pk_fma_f32 v[132:133], v[124:125], v[128:129], v[132:133] op_sel:[1,1,0] op_sel_hi:[0,1,1] neg_lo:[0,1,0]
    v_pk_fma_f32 v[134:135], v[126:127], v[128:129], v[134:135] op_sel:[1,1,0] op_sel_hi:[0,1,1] neg_lo:[0,1,0]
    v_pk_fma_f32 v[136:137], v[128:129], v[128:129], v[136:137] op_sel:[1,1,0] op_sel_hi:[0,1,1] neg_lo:[0,1,0]
    v_pk_mul_f32 v[138:139], v[130:131], v[128:129] op_sel:[0,0] op_sel_hi:[1,0]
    v_pk_mul_f32 v[140:141], v[132:133], v[128:129] op_sel:[0,0] op_sel_hi:[1,0]
    v_pk_mul_f32 v[142:143], v[134:135], v[128:129] op_sel:[0,0] op_sel_hi:[1,0]
    v_pk_mul_f32 v[144:145], v[136:137], v[128:129] op_sel:[0,0] op_sel_hi:[1,0]
    v_pk_fma_f32 v[138:139], v[130:131], v[128:129], v[138:139] op_sel:[1,1,0] op_sel_hi:[0,1,1] neg_lo:[0,1,0]
    v_pk_fma_f32 v[140:141], v[132:133], v[128:129], v[140:141] op_sel:[1,1,0] op_sel_hi:[0,1,1] neg_lo:[0,1,0]
    v_pk_fma_f32 v[142:143], v[134:135], v[128:129], v[142:143] op_sel:[1,1,0] op_sel_hi:[0,1,1] neg_lo:[0,1,0]
    v_pk_fma_f32 v[144:145], v[136:137], v[128:129], v[144:145] op_sel:[1,1,0] op_sel_hi:[0,1,1] neg_lo:[0,1,0]
    s_waitcnt lgkmcnt(7)
    s_nop 0
    v_mfma_f32_32x32x16_bf16 v[4:19], v[224:227], v[192:195], v[4:19]
    v_cvt_pk_bf16_f32 v190, v58, v59
    v_cvt_pk_bf16_f32 v191, v124, v125
    v_cvt_pk_bf16_f32 v184, v126, v127
    v_cvt_pk_bf16_f32 v185, v128, v129
    v_cvt_pk_bf16_f32 v186, v130, v131
    v_cvt_pk_bf16_f32 v187, v132, v133
    v_cvt_pk_bf16_f32 v188, v134, v135
    v_cvt_pk_bf16_f32 v189, v136, v137
    s_waitcnt lgkmcnt(6)
    s_nop 0
    v_mfma_f32_32x32x16_bf16 v[4:19], v[228:231], v[196:199], v[4:19]
    ds_write_addtid_b32 v190 offset:272
    ds_write_addtid_b32 v191 offset:544
    ds_write_addtid_b32 v184 offset:816
    ds_write_addtid_b32 v185 offset:1088
    ds_write_addtid_b32 v186 offset:1360
    ds_write_addtid_b32 v187 offset:1632
    ds_write_addtid_b32 v188 offset:1904
    ds_write_addtid_b32 v189 offset:2176
    v_pk_mul_f32 v[146:147], v[138:139], v[128:129] op_sel:[0,0] op_sel_hi:[1,0]
    v_pk_mul_f32 v[148:149], v[140:141], v[128:129] op_sel:[0,0] op_sel_hi:[1,0]
    v_pk_mul_f32 v[150:151], v[142:143], v[128:129] op_sel:[0,0] op_sel_hi:[1,0]
    v_pk_mul_f32 v[152:153], v[144:145], v[128:129] op_sel:[0,0] op_sel_hi:[1,0]
    v_pk_fma_f32 v[146:147], v[138:139], v[128:129], v[146:147] op_sel:[1,1,0] op_sel_hi:[0,1,1] neg_lo:[0,1,0]
    v_pk_fma_f32 v[148:149], v[140:141], v[128:129], v[148:149] op_sel:[1,1,0] op_sel_hi:[0,1,1] neg_lo:[0,1,0]
    v_pk_fma_f32 v[150:151], v[142:143], v[128:129], v[150:151] op_sel:[1,1,0] op_sel_hi:[0,1,1] neg_lo:[0,1,0]
    v_pk_fma_f32 v[152:153], v[144:145], v[128:129], v[152:153] op_sel:[1,1,0] op_sel_hi:[0,1,1] neg_lo:[0,1,0]
    v_pk_mul_f32 v[154:155], v[146:147], v[128:129] op_sel:[0,0] op_sel_hi:[1,0]
    v_pk_mul_f32 v[156:157], v[148:149], v[128:129] op_sel:[0,0] op_sel_hi:[1,0]
    v_pk_mul_f32 v[158:159], v[150:151], v[128:129] op_sel:[0,0] op_sel_hi:[1,0]
    v_pk_mul_f32 v[160:161], v[152:153], v[128:129] op_sel:[0,0] op_sel_hi:[1,0]
    v_pk_fma_f32 v[154:155], v[146:147], v[128:129], v[154:155] op_sel:[1,1,0] op_sel_hi:[0,1,1] neg_lo:[0,1,0]
    v_pk_fma_f32 v[156:157], v[148:149], v[128:129], v[156:157] op_sel:[1,1,0] op_sel_hi:[0,1,1] neg_lo:[0,1,0]
    v_pk_fma_f32 v[158:159], v[150:151], v[128:129], v[158:159] op_sel:[1,1,0] op_sel_hi:[0,1,1] neg_lo:[0,1,0]
    v_pk_fma_f32 v[160:161], v[152:153], v[128:129], v[160:161] op_sel:[1,1,0] op_sel_hi:[0,1,1] neg_lo:[0,1,0]
    s_waitcnt lgkmcnt(13)
    s_nop 0
    v_mfma_f32_32x32x16_bf16 v[4:19], v[232:235], v[200:203], v[4:19]
    v_cvt_pk_bf16_f32 v190, v138, v139
    v_cvt_pk_bf16_f32 v191, v140, v141
    v_cvt_pk_bf16_f32 v184, v142, v143
    v_cvt_pk_bf16_f32 v185, v144, v145
    v_cvt_pk_bf16_f32 v186, v146, v147
    v_cvt_pk_bf16_f32 v187, v148, v149
    v_cvt_pk_bf16_f32 v188, v150, v151
    v_cvt_pk_bf16_f32 v189, v152, v153
    s_waitcnt lgkmcnt(12)
    s_nop 0
    v_mfma_f32_32x32x16_bf16 v[4:19], v[236:239], v[204:207], v[4:19]
    ds_write_addtid_b32 v190 offset:2448
    ds_write_addtid_b32 v191 offset:2720
    ds_write_addtid_b32 v184 offset:2992
    ds_write_addtid_b32 v185 offset:3264
    ds_write_addtid_b32 v186 offset:3536
    ds_write_addtid_b32 v187 offset:3808
    ds_write_addtid_b32 v188 offset:4080
    ds_write_addtid_b32 v189 offset:4352
    v_pk_mul_f32 v[162:163], v[154:155], v[128:129] op_sel:[0,0] op_sel_hi:[1,0]
    v_pk_mul_f32 v[164:165], v[156:157], v[128:129] op_sel:[0,0] op_sel_hi:[1,0]
    v_pk_mul_f32 v[166:167], v[158:159], v[128:129] op_sel:[0,0] op_sel_hi:[1,0]
    v_pk_mul_f32 v[168:169], v[160:161], v[128:129] op_sel:[0,0] op_sel_hi:[1,0]
    v_pk_fma_f32 v[162:163], v[154:155], v[128:129], v[162:163] op_sel:[1,1,0] op_sel_hi:[0,1,1] neg_lo:[0,1,0]
    v_pk_fma_f32 v[164:165], v[156:157], v[128:129], v[164:165] op_sel:[1,1,0] op_sel_hi:[0,1,1] neg_lo:[0,1,0]
    v_pk_fma_f32 v[166:167], v[158:159], v[128:129], v[166:167] op_sel:[1,1,0] op_sel_hi:[0,1,1] neg_lo:[0,1,0]
    v_pk_fma_f32 v[168:169], v[160:161], v[128:129], v[168:169] op_sel:[1,1,0] op_sel_hi:[0,1,1] neg_lo:[0,1,0]
    v_pk_mul_f32 v[170:171], v[162:163], v[128:129] op_sel:[0,0] op_sel_hi:[1,0]
    v_pk_mul_f32 v[172:173], v[164:165], v[128:129] op_sel:[0,0] op_sel_hi:[1,0]
    v_pk_mul_f32 v[174:175], v[166:167], v[128:129] op_sel:[0,0] op_sel_hi:[1,0]
    v_pk_mul_f32 v[176:177], v[168:169], v[128:129] op_sel:[0,0] op_sel_hi:[1,0]
    v_pk_fma_f32 v[170:171], v[162:163], v[128:129], v[170:171] op_sel:[1,1,0] op_sel_hi:[0,1,1] neg_lo:[0,1,0]
    v_pk_fma_f32 v[172:173], v[164:165], v[128:129], v[172:173] op_sel:[1,1,0] op_sel_hi:[0,1,1] neg_lo:[0,1,0]
    v_pk_fma_f32 v[174:175], v[166:167], v[128:129], v[174:175] op_sel:[1,1,0] op_sel_hi:[0,1,1] neg_lo:[0,1,0]
    v_pk_fma_f32 v[176:177], v[168:169], v[128:129], v[176:177] op_sel:[1,1,0] op_sel_hi:[0,1,1] neg_lo:[0,1,0]
    s_waitcnt lgkmcnt(15)
    s_nop 0
    v_mfma_f32_32x32x16_bf16 v[4:19], v[76:79], v[208:211], v[4:19]
    v_cvt_pk_bf16_f32 v190, v154, v155
    v_cvt_pk_bf16_f32 v191, v156, v157
    v_cvt_pk_bf16_f32 v184, v158, v159
    v_cvt_pk_bf16_f32 v185, v160, v161
    v_cvt_pk_bf16_f32 v186, v162, v163
    v_cvt_pk_bf16_f32 v187, v164, v165
    v_cvt_pk_bf16_f32 v188, v166, v167
    v_cvt_pk_bf16_f32 v189, v168, v169
    v_mfma_f32_32x32x16_bf16 v[4:19], v[80:83], v[212:215], v[4:19]
    ds_write_addtid_b32 v190 offset:4624
    ds_write_addtid_b32 v191 offset:4896
    ds_write_addtid_b32 v184 offset:5168
    ds_write_addtid_b32 v185 offset:5440
    ds_write_addtid_b32 v186 offset:5712
    ds_write_addtid_b32 v187 offset:5984
    ds_write_addtid_b32 v188 offset:6256
    ds_write_addtid_b32 v189 offset:6528
    v_pk_mul_f32 v[178:179], v[170:171], v[128:129] op_sel:[0,0] op_sel_hi:[1,0]
    v_pk_mul_f32 v[180:181], v[172:173], v[128:129] op_sel:[0,0] op_sel_hi:[1,0]
    v_pk_mul_f32 v[182:183], v[174:175], v[128:129] op_sel:[0,0] op_sel_hi:[1,0]
    v_pk_fma_f32 v[178:179], v[170:171], v[128:129], v[178:179] op_sel:[1,1,0] op_sel_hi:[0,1,1] neg_lo:[0,1,0]
    v_pk_fma_f32 v[180:181], v[172:173], v[128:129], v[180:181] op_sel:[1,1,0] op_sel_hi:[0,1,1] neg_lo:[0,1,0]
    v_pk_fma_f32 v[182:183], v[174:175], v[128:129], v[182:183] op_sel:[1,1,0] op_sel_hi:[0,1,1] neg_lo:[0,1,0]
    ds_write_addtid_b32 v21
    v_mfma_f32_32x32x16_bf16 v[4:19], v[84:87], v[216:219], v[4:19]
    v_cvt_pk_bf16_f32 v190, v170, v171
    v_cvt_pk_bf16_f32 v191, v172, v173
    v_cvt_pk_bf16_f32 v184, v174, v175
    v_cvt_pk_bf16_f32 v185, v176, v177
    v_cvt_pk_bf16_f32 v186, v178, v179
    v_cvt_pk_bf16_f32 v187, v180, v181
    v_cvt_pk_bf16_f32 v188, v182, v183
    v_mfma_f32_32x32x16_bf16 v[4:19], v[88:91], v[220:223], v[4:19]
    ds_write_addtid_b32 v190 offset:6800
    ds_write_addtid_b32 v191 offset:7072
    ds_write_addtid_b32 v184 offset:7344
    ds_write_addtid_b32 v185 offset:7616
    ds_write_addtid_b32 v186 offset:7888
    ds_write_addtid_b32 v187 offset:8160
    ds_write_addtid_b32 v188 offset:8432
    ds_read_b128 v[192:195], v20 offset:0
    ds_read_b128 v[196:199], v20 offset:32
    ds_read_b128 v[200:203], v20 offset:64
    ds_read_b128 v[204:207], v20 offset:96
    ds_read_b128 v[208:211], v20 offset:128
    ds_read_b128 v[212:215], v20 offset:160
    ds_read_b128 v[216:219], v20 offset:192
    ds_read_b128 v[220:223], v20 offset:224
    buffer_load_dword v1, v240, s[60:63], 0 offen sc0 sc1
    global_load_dword v2, v3, s[42:43] sc0 sc1
    v_pk_mul_f32 v[122:123], v[66:67], v[56:57] op_sel:[0,0] op_sel_hi:[1,0]
    v_pk_mul_f32 v[124:125], v[66:67], v[62:63] op_sel:[0,0] op_sel_hi:[1,0]
    v_pk_mul_f32 v[128:129], v[66:67], v[64:65] op_sel:[0,0] op_sel_hi:[1,0]
    v_pk_mul_f32 v[136:137], v[66:67], v[58:59] op_sel:[0,0] op_sel_hi:[1,0]
    v_pk_mul_f32 v[138:139], v[66:67], v[60:61] op_sel:[0,0] op_sel_hi:[1,0]
    v_pk_fma_f32 v[122:123], v[66:67], v[56:57], v[122:123] op_sel:[1,1,0] op_sel_hi:[0,1,1] neg_lo:[0,1,0]
    v_pk_fma_f32 v[124:125], v[66:67], v[62:63], v[124:125] op_sel:[1,1,0] op_sel_hi:[0,1,1] neg_lo:[0,1,0]
    v_pk_fma_f32 v[128:129], v[66:67], v[64:65], v[128:129] op_sel:[1,1,0] op_sel_hi:[0,1,1] neg_lo:[0,1,0]
    v_pk_fma_f32 v[136:137], v[66:67], v[58:59], v[136:137] op_sel:[1,1,0] op_sel_hi:[0,1,1] neg_lo:[0,1,0]
    v_pk_fma_f32 v[138:139], v[66:67], v[60:61], v[138:139] op_sel:[1,1,0] op_sel_hi:[0,1,1] neg_lo:[0,1,0]
    v_pk_mul_f32 v[126:127], v[124:125], v[56:57] op_sel:[0,0] op_sel_hi:[1,0]
    v_pk_mul_f32 v[130:131], v[128:129], v[56:57] op_sel:[0,0] op_sel_hi:[1,0]
    v_pk_mul_f32 v[140:141], v[138:139], v[62:63] op_sel:[0,0] op_sel_hi:[1,0]
    v_pk_mul_f32 v[148:149], v[138:139], v[60:61] op_sel:[0,0] op_sel_hi:[1,0]
    v_pk_fma_f32 v[126:127], v[124:125], v[56:57], v[126:127] op_sel:[1,1,0] op_sel_hi:[0,1,1] neg_lo:[0,1,0]
    v_pk_fma_f32 v[130:131], v[128:129], v[56:57], v[130:131] op_sel:[1,1,0] op_sel_hi:[0,1,1] neg_lo:[0,1,0]
    v_pk_fma_f32 v[140:141], v[138:139], v[62:63], v[140:141] op_sel:[1,1,0] op_sel_hi:[0,1,1] neg_lo:[0,1,0]
    v_pk_fma_f32 v[148:149], v[138:139], v[60:61], v[148:149] op_sel:[1,1,0] op_sel_hi:[0,1,1] neg_lo:[0,1,0]
    v_cvt_pk_bf16_f32 v189, v66, -v67
    v_cvt_pk_bf16_f32 v190, v122, -v123
    v_cvt_pk_bf16_f32 v191, v124, -v125
    v_cvt_pk_bf16_f32 v184, v128, -v129
    v_cvt_pk_bf16_f32 v185, v136, -v137
    v_cvt_pk_bf16_f32 v186, v138, -v139
    ds_write_addtid_b32 v189 offset:0
    ds_write_addtid_b32 v190 offset:272
    ds_write_addtid_b32 v191 offset:544
    ds_write_addtid_b32 v184 offset:2176
    ds_write_addtid_b32 v185 offset:4352
    ds_write_addtid_b32 v186 offset:1088
    ds_write_addtid_b32 v186 offset:1360
    v_pk_mul_f32 v[132:133], v[128:129], v[62:63] op_sel:[0,0] op_sel_hi:[1,0]
    v_pk_mul_f32 v[142:143], v[138:139], v[64:65] op_sel:[0,0] op_sel_hi:[1,0]
    v_pk_mul_f32 v[146:147], v[138:139], v[58:59] op_sel:[0,0] op_sel_hi:[1,0]
    v_pk_mul_f32 v[154:155], v[148:149], v[60:61] op_sel:[0,0] op_sel_hi:[1,0]
    v_pk_fma_f32 v[132:133], v[128:129], v[62:63], v[132:133] op_sel:[1,1,0] op_sel_hi:[0,1,1] neg_lo:[0,1,0]
    v_pk_fma_f32 v[142:143], v[138:139], v[64:65], v[142:143] op_sel:[1,1,0] op_sel_hi:[0,1,1] neg_lo:[0,1,0]
    v_pk_fma_f32 v[146:147], v[138:139], v[58:59], v[146:147] op_sel:[1,1,0] op_sel_hi:[0,1,1] neg_lo:[0,1,0]
    v_pk_fma_f32 v[154:155], v[148:149], v[60:61], v[154:155] op_sel:[1,1,0] op_sel_hi:[0,1,1] neg_lo:[0,1,0]
    v_pk_mul_f32 v[134:135], v[132:133], v[56:57] op_sel:[0,0] op_sel_hi:[1,0]
    v_pk_mul_f32 v[144:145], v[142:143], v[62:63] op_sel:[0,0] op_sel_hi:[1,0]
    v_pk_mul_f32 v[150:151], v[148:149], v[64:65] op_sel:[0,0] op_sel_hi:[1,0]
    v_pk_mul_f32 v[160:161], v[154:155], v[60:61] op_sel:[0,0] op_sel_hi:[1,0]
    v_pk_fma_f32 v[134:135], v[132:133], v[56:57], v[134:135] op_sel:[1,1,0] op_sel_hi:[0,1,1] neg_lo:[0,1,0]
    v_pk_fma_f32 v[144:145], v[142:143], v[62:63], v[144:145] op_sel:[1,1,0] op_sel_hi:[0,1,1] neg_lo:[0,1,0]
    v_pk_fma_f32 v[150:151], v[148:149], v[64:65], v[150:151] op_sel:[1,1,0] op_sel_hi:[0,1,1] neg_lo:[0,1,0]
    v_pk_fma_f32 v[160:161], v[154:155], v[60:61], v[160:161] op_sel:[1,1,0] op_sel_hi:[0,1,1] neg_lo:[0,1,0]
    v_cvt_pk_bf16_f32 v187, v126, -v127
    v_cvt_pk_bf16_f32 v188, v130, -v131
    v_cvt_pk_bf16_f32 v189, v140, -v141
    v_cvt_pk_bf16_f32 v190, v148, -v149
    v_cvt_pk_bf16_f32 v191, v132, -v133
    v_cvt_pk_bf16_f32 v184, v142, -v143
    v_cvt_pk_bf16_f32 v185, v146, -v147
    v_cvt_pk_bf16_f32 v186, v154, -v155
    ds_write_addtid_b32 v187 offset:816
    ds_write_addtid_b32 v188 offset:2448
    ds_write_addtid_b32 v189 offset:1632
    ds_write_addtid_b32 v190 offset:4624
    ds_write_addtid_b32 v191 offset:2720
    ds_write_addtid_b32 v184 offset:1904
    ds_write_addtid_b32 v184 offset:3264
    ds_write_addtid_b32 v184 offset:3536
    ds_write_addtid_b32 v185 offset:4080
    ds_write_addtid_b32 v185 offset:5440
    ds_write_addtid_b32 v186 offset:5712
    s_waitcnt vmcnt(0)
    v_readfirstlane_b32 s10, v2
    s_nop 1
    v_xor_b32 v1, s10, v1
    v_cmp_eq_u32 vcc, 0, v2
    s_nop 1
    v_cndmask_b32 v1, v1, 1, vcc
    v_cmp_ne_u32 vcc, 0, v1
    s_nop 0
    s_mov_b64 s[46:47], vcc
    s_nop 0
    v_pk_mul_f32 v[152:153], v[148:149], v[58:59] op_sel:[0,0] op_sel_hi:[1,0]
    v_pk_mul_f32 v[156:157], v[154:155], v[64:65] op_sel:[0,0] op_sel_hi:[1,0]
    v_pk_mul_f32 v[158:159], v[154:155], v[58:59] op_sel:[0,0] op_sel_hi:[1,0]
    v_pk_mul_f32 v[164:165], v[160:161], v[60:61] op_sel:[0,0] op_sel_hi:[1,0]
    v_pk_fma_f32 v[152:153], v[148:149], v[58:59], v[152:153] op_sel:[1,1,0] op_sel_hi:[0,1,1] neg_lo:[0,1,0]
    v_pk_fma_f32 v[156:157], v[154:155], v[64:65], v[156:157] op_sel:[1,1,0] op_sel_hi:[0,1,1] neg_lo:[0,1,0]
    s_cbranch_vccnz .Lxsb0
    s_add_u32 s77, s80, 0
    s_and_b32 s77, s77, 7
    s_mul_i32 s77, s77, 5120
    s_add_u32 s77, s77, s76
    buffer_load_dwordx4 a[120:123], v253, s[60:63], s77 offen offset:0 sc1
.Lxsb0:
    v_pk_fma_f32 v[158:159], v[154:155], v[58:59], v[158:159] op_sel:[1,1,0] op_sel_hi:[0,1,1] neg_lo:[0,1,0]
    v_pk_fma_f32 v[164:165], v[160:161], v[60:61], v[164:165] op_sel:[1,1,0] op_sel_hi:[0,1,1] neg_lo:[0,1,0]
    v_pk_mul_f32 v[162:163], v[160:161], v[58:59] op_sel:[0,0] op_sel_hi:[1,0]
    v_pk_mul_f32 v[166:167], v[164:165], v[58:59] op_sel:[0,0] op_sel_hi:[1,0]
    v_pk_mul_f32 v[168:169], v[164:165], v[60:61] op_sel:[0,0] op_sel_hi:[1,0]
    v_pk_fma_f32 v[162:163], v[160:161], v[58:59], v[162:163] op_sel:[1,1,0] op_sel_hi:[0,1,1] neg_lo:[0,1,0]
    s_cbranch_vccnz .Lxsb1
    s_nop 0
    buffer_load_dwordx4 a[124:127], v253, s[60:63], s77 offen offset:1024 sc1
.Lxsb1:
    v_pk_fma_f32 v[166:167], v[164:165], v[58:59], v[166:167] op_sel:[1,1,0] op_sel_hi:[0,1,1] neg_lo:[0,1,0]
    v_pk_fma_f32 v[168:169], v[164:165], v[60:61], v[168:169] op_sel:[1,1,0] op_sel_hi:[0,1,1] neg_lo:[0,1,0]
    v_cvt_pk_bf16_f32 v187, v134, -v135
    v_cvt_pk_bf16_f32 v188, v144, -v145
    v_cvt_pk_bf16_f32 v189, v150, -v151
    v_cvt_pk_bf16_f32 v190, v160, -v161
    s_cbranch_vccnz .Lxsb2
    s_nop 0
    buffer_load_dwordx4 a[128:131], v253, s[60:63], s77 offen offset:2048 sc1
.Lxsb2:
    v_cvt_pk_bf16_f32 v191, v152, -v153
    v_cvt_pk_bf16_f32 v184, v156, -v157
    v_cvt_pk_bf16_f32 v185, v158, -v159
    v_cvt_pk_bf16_f32 v186, v164, -v165
    ds_write_addtid_b32 v187 offset:2992
    ds_write_addtid_b32 v188 offset:3808
    s_cbranch_vccnz .Lxsb3
    s_nop 0
    buffer_load_dwordx4 a[132:135], v253, s[60:63], s77 offen offset:3072 sc1
.Lxsb3:
    ds_write_addtid_b32 v189 offset:4896
    ds_write_addtid_b32 v190 offset:6528
    ds_write_addtid_b32 v191 offset:5168
    ds_write_addtid_b32 v184 offset:5984
    ds_write_addtid_b32 v185 offset:6256
    ds_write_addtid_b32 v186 offset:7072
    s_cbranch_vccnz .Lxsb4
    s_nop 0
    buffer_load_dwordx4 a[136:139], v252, s[60:63], s77 offen offset:3072 sc1
.Lxsb4:
    v_pk_mul_f32 v[170:171], v[168:169], v[58:59] op_sel:[0,0] op_sel_hi:[1,0]
    v_pk_mul_f32 v[172:173], v[168:169], v[60:61] op_sel:[0,0] op_sel_hi:[1,0]
    v_pk_fma_f32 v[170:171], v[168:169], v[58:59], v[170:171] op_sel:[1,1,0] op_sel_hi:[0,1,1] neg_lo:[0,1,0]
    v_pk_fma_f32 v[172:173], v[168:169], v[60:61], v[172:173] op_sel:[1,1,0] op_sel_hi:[0,1,1] neg_lo:[0,1,0]
    v_pk_mul_f32 v[174:175], v[172:173], v[58:59] op_sel:[0,0] op_sel_hi:[1,0]
    v_pk_fma_f32 v[174:175], v[172:173], v[58:59], v[174:175] op_sel:[1,1,0] op_sel_hi:[0,1,1] neg_lo:[0,1,0]
    s_cbranch_vccnz .Lxsb5
    s_add_u32 s77, s80, 1
    s_and_b32 s77, s77, 7
    s_mul_i32 s77, s77, 5120
    s_add_u32 s77, s77, s76
    buffer_load_dwordx4 a[140:143], v253, s[60:63], s77 offen offset:0 sc1
.Lxsb5:
    v_cvt_pk_bf16_f32 v187, v162, -v163
    v_cvt_pk_bf16_f32 v188, v166, -v167
    v_cvt_pk_bf16_f32 v189, v168, -v169
    v_cvt_pk_bf16_f32 v190, v170, -v171
    v_cvt_pk_bf16_f32 v191, v172, -v173
    v_cvt_pk_bf16_f32 v184, v174, -v175
    s_cbranch_vccnz .Lxsb6
    s_nop 0
    buffer_load_dwordx4 a[144:147], v253, s[60:63], s77 offen offset:1024 sc1
.Lxsb6:
    ds_write_addtid_b32 v187 offset:6800
    ds_write_addtid_b32 v188 offset:7344
    ds_write_addtid_b32 v189 offset:7616
    ds_write_addtid_b32 v190 offset:7888
    ds_write_addtid_b32 v191 offset:8160
    ds_write_addtid_b32 v184 offset:8432
    s_cbranch_vccnz .Lxsb7
    s_nop 0
    buffer_load_dwordx4 a[148:151], v253, s[60:63], s77 offen offset:2048 sc1
.Lxsb7:
    ds_read_b128 v[224:227], v20 offset:0
    ds_read_b128 v[228:231], v20 offset:32
    ds_read_b128 v[232:235], v20 offset:64
    ds_read_b128 v[236:239], v20 offset:96
    ds_read_b128 v[76:79], v20 offset:128
    ds_read_b128 v[80:83], v20 offset:160
    ds_read_b128 v[84:87], v20 offset:192
    ds_read_b128 v[88:91], v20 offset:224
    s_waitcnt lgkmcnt(7)
    v_mfma_f32_32x32x16_bf16 v[4:19], v[224:227], v[192:195], v[4:19]
    s_waitcnt lgkmcnt(6)
    v_mfma_f32_32x32x16_bf16 v[4:19], v[228:231], v[196:199], v[4:19]
    s_waitcnt lgkmcnt(5)
    v_mfma_f32_32x32x16_bf16 v[4:19], v[232:235], v[200:203], v[4:19]
    s_waitcnt lgkmcnt(4)
    v_mfma_f32_32x32x16_bf16 v[4:19], v[236:239], v[204:207], v[4:19]
    s_waitcnt lgkmcnt(3)
    v_mfma_f32_32x32x16_bf16 v[4:19], v[76:79], v[208:211], v[4:19]
    s_waitcnt lgkmcnt(2)
    v_mfma_f32_32x32x16_bf16 v[4:19], v[80:83], v[212:215], v[4:19]
    s_waitcnt lgkmcnt(1)
    v_mfma_f32_32x32x16_bf16 v[4:19], v[84:87], v[216:219], v[4:19]
    s_waitcnt lgkmcnt(0)
    v_mfma_f32_32x32x16_bf16 v[4:19], v[88:91], v[220:223], v[4:19]
    v_and_b32 v236, 1, v0
    v_cmp_eq_u32 vcc, 1, v236
    s_nop 9
    s_nop 0
    v_cvt_pk_bf16_f32 v156, v11, v10
    v_cvt_pk_bf16_f32 v157, v9, v8
    v_cvt_pk_bf16_f32 v158, v7, v6
    v_cvt_pk_bf16_f32 v159, v5, v4
    v_cvt_pk_bf16_f32 v160, v12, v11
    v_cvt_pk_bf16_f32 v161, v10, v9
    v_cvt_pk_bf16_f32 v162, v8, v7
    v_cvt_pk_bf16_f32 v163, v6, v5
    v_add_u32 v236, 7452, v248
    ds_write_b128 v248, v[156:159] offset:3168
    ds_write2_b32 v236, v160, v161 offset0:0 offset1:1
    ds_write2_b32 v236, v162, v163 offset0:2 offset1:3
    v_cvt_pk_bf16_f32 v164, v15, v15
    v_cvt_pk_bf16_f32 v165, v14, v14
    v_cvt_pk_bf16_f32 v166, v14, v13
    v_cvt_pk_bf16_f32 v167, v13, v13
    v_cvt_pk_bf16_f32 v168, v15, v15
    v_cvt_pk_bf16_f32 v169, v15, v14
    v_cvt_pk_bf16_f32 v170, v14, v14
    v_cvt_pk_bf16_f32 v171, v13, v13
    v_add_u32 v236, 6396, v248
    ds_write_b128 v248, v[164:167] offset:2112
    ds_write2_b32 v236, v168, v169 offset0:0 offset1:1
    ds_write2_b32 v236, v170, v171 offset0:2 offset1:3
    v_cndmask_b32_e64 v237, v16, v17, vcc
    v_cvt_pk_bf16_f32 v172, v17, v17
    v_cvt_pk_bf16_f32 v173, v17, v237
    v_cvt_pk_bf16_f32 v174, v16, v16
    v_cvt_pk_bf16_f32 v175, v16, v16
    v_cvt_pk_bf16_f32 v176, v17, v17
    v_cvt_pk_bf16_f32 v177, v17, v17
    v_cvt_pk_bf16_f32 v178, v237, v16
    v_cvt_pk_bf16_f32 v179, v16, v16
    v_add_u32 v236, 4796, v249
    ds_write_b128 v249, v[172:175] offset:512
    ds_write2_b32 v236, v176, v177 offset0:0 offset1:1
    ds_write2_b32 v236, v178, v179 offset0:2 offset1:3
    v_cndmask_b32_e64 v237, v18, v19, vcc
    v_cvt_pk_bf16_f32 v180, v19, v19
    v_cvt_pk_bf16_f32 v181, v19, v237
    v_cvt_pk_bf16_f32 v182, v18, v18
    v_cvt_pk_bf16_f32 v183, v18, v18
    v_cvt_pk_bf16_f32 v184, v19, v19
    v_cvt_pk_bf16_f32 v185, v19, v19
    v_cvt_pk_bf16_f32 v186, v237, v18
    v_cvt_pk_bf16_f32 v187, v18, v18
    v_add_u32 v236, 4284, v249
    ds_write_b128 v249, v[180:183] offset:0
    ds_write2_b32 v236, v184, v185 offset0:0 offset1:1
    ds_write2_b32 v236, v186, v187 offset0:2 offset1:3
    v_mov_b32 v172, 0
    v_mov_b32 v173, 0
    v_mov_b32 v174, 0
    v_mov_b32 v175, 0
    v_cvt_pk_bf16_f32 v176, v4, 0
    v_mov_b32 v237, s78
    v_subrev_u32 v249, 32, v249
    s_mov_b32 exec_lo, 0
    s_nop 0
    s_mov_b32 exec_hi, 0x80000000
    ds_write_b128 v248, v[156:159] offset:3136
    ds_write_b128 v248, v[164:167] offset:2080
    v_add_u32 v236, 7420, v248
    ds_write2_b32 v236, v160, v161 offset0:0 offset1:1
    ds_write2_b32 v236, v162, v163 offset0:2 offset1:3
    v_add_u32 v236, 6364, v248
    ds_write2_b32 v236, v168, v169 offset0:0 offset1:1
    ds_write2_b32 v236, v170, v171 offset0:2 offset1:3
    s_mov_b32 exec_lo, 0x80000000
    s_mov_b32 exec_hi, 0
    ds_write_b128 v249, v[180:183]
    v_add_u32 v236, 4284, v249
    ds_write2_b32 v236, v184, v185 offset0:0 offset1:1
    ds_write2_b32 v236, v186, v187 offset0:2 offset1:3
    s_mov_b32 exec_lo, 1
    ds_write_b128 v237, v[172:175] offset:4192
    v_add_u32 v237, 8476, v237
    ds_write2_b32 v237, v176, v172 offset0:0 offset1:1
    ds_write2_b32 v237, v172, v172 offset0:2 offset1:3
    s_mov_b64 exec, -1
    s_cmp_lg_u64 s[46:47], 0
    s_cbranch_scc1 .Lxs
.Lxb:
.Lk3:
    s_barrier
    ds_read_b64_tr_b16 v[120:121], v254 offset:0
    ds_read_b64_tr_b16 v[122:123], v254 offset:768
    ds_read_b64_tr_b16 v[124:125], v254 offset:64
    ds_read_b64_tr_b16 v[126:127], v254 offset:832
    ds_read_b64_tr_b16 v[128:129], v254 offset:128
    ds_read_b64_tr_b16 v[130:131], v254 offset:896
    ds_read_b64_tr_b16 v[132:133], v254 offset:3072
    ds_read_b64_tr_b16 v[134:135], v254 offset:3840
    ds_read_b64_tr_b16 v[136:137], v254 offset:3136
    ds_read_b64_tr_b16 v[138:139], v254 offset:3904
    ds_read_b64_tr_b16 v[140:141], v254 offset:3200
    ds_read_b64_tr_b16 v[142:143], v254 offset:3968
    s_mul_i32 s13, s3, 3
    s_add_u32 s13, s13, 28
    s_mul_i32 s70, s13, 3072
    s_add_u32 s70, s70, 40960
    s_and_b32 s12, s80, 7
    s_mul_i32 s12, s12, 5
    s_add_u32 s12, s12, s13
    s_cmp_ge_u32 s12, 40
    s_cselect_b32 s13, 40, 0
    s_sub_u32 s12, s12, s13
    s_mul_i32 s71, s12, 49152
    s_add_u32 s71, s71, s81
    s_mov_b32 s14, s81
    s_mov_b32 s15, s74
    s_mul_i32 s81, s3, 491520
    s_mul_i32 s11, s7, 5120
    s_add_u32 s81, s81, s11
    s_add_u32 s81, s81, 23027712
    s_and_b32 s11, s6, 0
    s_mul_i32 s12, s11, 245760
    s_add_u32 s81, s81, s12
    s_mul_i32 s22, s11, 491520
    s_mul_i32 s11, s11, 6144
    s_sub_u32 s18, s90, s11
    s_add_u32 s90, s90, s11
    s_sub_u32 s19, s91, s11
    s_add_u32 s91, s91, s11
    s_sub_u32 s20, s92, s11
    s_add_u32 s92, s92, s11
    s_sub_u32 s21, s93, s11
    s_add_u32 s93, s93, s11
    s_waitcnt vmcnt(7) lgkmcnt(10)
    v_mfma_f32_32x32x16_bf16 v[20:35], v[120:123], a[120:123], 0
    ds_read_b64_tr_b16 v[144:145], v254 offset:6144
    ds_read_b64_tr_b16 v[146:147], v254 offset:6912
    buffer_load_dwordx4 a[152:155], v253, s[60:63], s77 offen offset:3072 sc1
    s_waitcnt lgkmcnt(10)
    v_mfma_f32_32x32x16_bf16 v[36:51], v[124:127], a[120:123], 0
    ds_read_b64_tr_b16 v[148:149], v254 offset:6208
    ds_read_b64_tr_b16 v[150:151], v254 offset:6976
    s_waitcnt lgkmcnt(10)
    v_mfma_f32_32x32x16_bf16 v[52:67], v[128:131], a[120:123], 0
    ds_read_b64_tr_b16 v[152:153], v254 offset:6272
    ds_read_b64_tr_b16 v[154:155], v254 offset:7040
    buffer_load_dwordx4 a[156:159], v252, s[60:63], s77 offen offset:3072 sc1
    s_waitcnt vmcnt(8) lgkmcnt(10)
    v_mfma_f32_32x32x16_bf16 v[20:35], v[132:135], a[124:127], v[20:35]
    ds_read_b64 v[68:69], v245 offset:0
    ds_read_b64_tr_b16 v[120:121], v254 offset:9216
    ds_read_b64_tr_b16 v[122:123], v254 offset:9984
    s_waitcnt lgkmcnt(11)
    v_mfma_f32_32x32x16_bf16 v[36:51], v[136:139], a[124:127], v[36:51]
    s_add_u32 m0, s70, 0
    s_nop 0
    buffer_load_dwordx4 v241, s[52:55], s71 offen lds
    ds_read_b64_tr_b16 v[124:125], v254 offset:9280
    ds_read_b64_tr_b16 v[126:127], v254 offset:10048
    s_add_u32 s77, s80, 2
    s_and_b32 s77, s77, 7
    s_mul_i32 s77, s77, 5120
    s_add_u32 s77, s77, s76
    buffer_load_dwordx4 a[160:163], v253, s[60:63], s77 offen offset:0 sc1
    s_waitcnt lgkmcnt(11)
    v_mfma_f32_32x32x16_bf16 v[52:67], v[140:143], a[124:127], v[52:67]
    ds_read_b64 v[70:71], v245 offset:16
    ds_read_b64_tr_b16 v[128:129], v254 offset:9344
    ds_read_b64_tr_b16 v[130:131], v254 offset:10112
    s_waitcnt vmcnt(9) lgkmcnt(12)
    v_mfma_f32_32x32x16_bf16 v[20:35], v[144:147], a[128:131], v[20:35]
    ds_read_b64_tr_b16 v[132:133], v254 offset:12288
    ds_read_b64_tr_b16 v[134:135], v254 offset:13056
    buffer_load_dwordx4 a[164:167], v253, s[60:63], s77 offen offset:1024 sc1
    s_waitcnt lgkmcnt(12)
    v_mfma_f32_32x32x16_bf16 v[36:51], v[148:151], a[128:131], v[36:51]
    ds_read_b64 v[72:73], v245 offset:32
    ds_read_b64_tr_b16 v[136:137], v254 offset:12352
    ds_read_b64_tr_b16 v[138:139], v254 offset:13120
    s_waitcnt lgkmcnt(13)
    v_mfma_f32_32x32x16_bf16 v[52:67], v[152:155], a[128:131], v[52:67]
    s_add_u32 m0, s70, 1024
    s_nop 0
    buffer_load_dwordx4 v242, s[52:55], s71 offen lds
    ds_read_b64_tr_b16 v[140:141], v254 offset:12416
    ds_read_b64_tr_b16 v[142:143], v254 offset:13184
    buffer_load_dwordx4 a[168:171], v253, s[60:63], s77 offen offset:2048 sc1
    s_waitcnt vmcnt(11) lgkmcnt(12)
    v_mfma_f32_32x32x16_bf16 v[20:35], v[120:123], a[132:135], v[20:35]
    ds_read_b64 v[74:75], v245 offset:48
    ds_read_b64_tr_b16 v[144:145], v254 offset:15360
    ds_read_b64_tr_b16 v[146:147], v254 offset:16128
    s_waitcnt lgkmcnt(13)
    v_mfma_f32_32x32x16_bf16 v[36:51], v[124:127], a[132:135], v[36:51]
    ds_read_b64_tr_b16 v[148:149], v254 offset:15424
    ds_read_b64_tr_b16 v[150:151], v254 offset:16192
    buffer_load_dwordx4 a[172:175], v253, s[60:63], s77 offen offset:3072 sc1
    s_waitcnt lgkmcnt(12)
    v_mfma_f32_32x32x16_bf16 v[52:67], v[128:131], a[132:135], v[52:67]
    ds_read_b64 v[76:77], v245 offset:64
    ds_read_b64_tr_b16 v[152:153], v254 offset:15488
    ds_read_b64_tr_b16 v[154:155], v254 offset:16256
    s_waitcnt vmcnt(11) lgkmcnt(13)
    v_mfma_f32_32x32x16_bf16 v[20:35], v[132:135], a[136:139], v[20:35]
    s_add_u32 m0, s70, 2048
    s_nop 0
    buffer_load_dwordx4 v243, s[52:55], s71 offen lds
    s_add_u32 s70, s70, 3072
    s_add_u32 s71, s71, 49152
    s_cmp_eq_u32 s71, s15
    s_cselect_b32 s71, s14, s71
    ds_read_b64_tr_b16 v[120:121], v254 offset:18432
    ds_read_b64_tr_b16 v[122:123], v254 offset:19200
    buffer_load_dwordx4 a[176:179], v252, s[60:63], s77 offen offset:3072 sc1
    s_waitcnt lgkmcnt(12)
    v_mfma_f32_32x32x16_bf16 v[36:51], v[136:139], a[136:139], v[36:51]
    ds_read_b64 v[78:79], v245 offset:80
    ds_read_b64_tr_b16 v[124:125], v254 offset:18496
    ds_read_b64_tr_b16 v[126:127], v254 offset:19264
    s_waitcnt lgkmcnt(13)
    v_mfma_f32_32x32x16_bf16 v[52:67], v[140:143], a[136:139], v[52:67]
    s_mov_b32 s72, 0x00003f80
    ds_read_b64_tr_b16 v[128:129], v254 offset:18560
    ds_read_b64_tr_b16 v[130:131], v254 offset:19328
    s_waitcnt vmcnt(12) lgkmcnt(12)
    v_mfma_f32_32x32x16_bf16 v[20:35], v[144:147], a[140:143], v[20:35]
    ds_read_b64 v[80:81], v245 offset:96
    s_mov_b32 s73, 0x3f800000
    ds_read_b64_tr_b16 v[132:133], v254 offset:21504
    ds_read_b64_tr_b16 v[134:135], v254 offset:22272
    s_waitcnt lgkmcnt(13)
    v_mfma_f32_32x32x16_bf16 v[36:51], v[148:151], a[140:143], v[36:51]
    s_add_u32 m0, s70, 0
    s_nop 0
    buffer_load_dwordx4 v241, s[52:55], s71 offen lds
    s_mul_i32 s12, s97, 4352
    ds_read_b64_tr_b16 v[136:137], v254 offset:21568
    ds_read_b64_tr_b16 v[138:139], v254 offset:22336
    s_add_u32 s77, s80, 3
    s_and_b32 s77, s77, 7
    s_mul_i32 s77, s77, 5120
    s_add_u32 s77, s77, s76
    buffer_load_dwordx4 a[180:183], v253, s[60:63], s77 offen offset:0 sc1
    s_waitcnt lgkmcnt(12)
    v_mfma_f32_32x32x16_bf16 v[52:67], v[152:155], a[140:143], v[52:67]
    ds_read_b64 v[82:83], v245 offset:112
    ds_read_b64_tr_b16 v[140:141], v254 offset:21632
    ds_read_b64_tr_b16 v[142:143], v254 offset:22400
    s_waitcnt vmcnt(13) lgkmcnt(13)
    v_mfma_f32_32x32x16_bf16 v[20:35], v[120:123], a[144:147], v[20:35]
    v_add_u32 v92, s12, v101
    ds_read_b64_tr_b16 v[144:145], v254 offset:24576
    ds_read_b64_tr_b16 v[146:147], v254 offset:25344
    buffer_load_dwordx4 a[184:187], v253, s[60:63], s77 offen offset:1024 sc1
    s_waitcnt lgkmcnt(12)
    v_mfma_f32_32x32x16_bf16 v[36:51], v[124:127], a[144:147], v[36:51]
    ds_read_b64 v[84:85], v245 offset:128
    s_mul_i32 s12, s97, 8704
    ds_read_b64_tr_b16 v[148:149], v254 offset:24640
    ds_read_b64_tr_b16 v[150:151], v254 offset:25408
    s_waitcnt lgkmcnt(13)
    v_mfma_f32_32x32x16_bf16 v[52:67], v[128:131], a[144:147], v[52:67]
    s_add_u32 m0, s70, 1024
    s_nop 0
    buffer_load_dwordx4 v242, s[52:55], s71 offen lds
    ds_read_b64_tr_b16 v[152:153], v254 offset:24704
    ds_read_b64_tr_b16 v[154:155], v254 offset:25472
    s_waitcnt vmcnt(14) lgkmcnt(12)
    s_nop 0
    v_mfma_f32_32x32x16_bf16 v[20:35], v[132:135], a[148:151], v[20:35]
    ds_read_b64 v[86:87], v245 offset:144
    s_mul_i32 s13, s99, 2112
    ds_read_b64_tr_b16 v[120:121], v254 offset:27648
    ds_read_b64_tr_b16 v[122:123], v254 offset:28416
    s_waitcnt lgkmcnt(13)
    v_mfma_f32_32x32x16_bf16 v[36:51], v[136:139], a[148:151], v[36:51]
    s_add_u32 s12, s12, s13
    ds_read_b64_tr_b16 v[124:125], v254 offset:27712
    ds_read_b64_tr_b16 v[126:127], v254 offset:28480
    buffer_load_dwordx4 a[188:191], v253, s[60:63], s77 offen offset:2048 sc1
    s_waitcnt lgkmcnt(12)
    v_mfma_f32_32x32x16_bf16 v[52:67], v[140:143], a[148:151], v[52:67]
    ds_read_b64 v[88:89], v245 offset:160
    ds_read_b64_tr_b16 v[128:129], v254 offset:27776
    ds_read_b64_tr_b16 v[130:131], v254 offset:28544
    s_waitcnt vmcnt(14) lgkmcnt(13)
    v_mfma_f32_32x32x16_bf16 v[20:35], v[144:147], a[152:155], v[20:35]
    s_add_u32 m0, s70, 2048
    s_nop 0
    buffer_load_dwordx4 v243, s[52:55], s71 offen lds
    s_add_u32 s70, s70, 3072
    s_add_u32 s71, s71, 49152
    s_cmp_eq_u32 s71, s15
    s_cselect_b32 s71, s14, s71
    v_add_u32 v93, s12, v102
    ds_read_b64_tr_b16 v[132:133], v254 offset:30720
    ds_read_b64_tr_b16 v[134:135], v254 offset:31488
    buffer_load_dwordx4 a[192:195], v253, s[60:63], s77 offen offset:3072 sc1
    s_waitcnt lgkmcnt(12)
    s_nop 0
    v_mfma_f32_32x32x16_bf16 v[36:51], v[148:151], a[152:155], v[36:51]
    ds_read_b64 v[90:91], v245 offset:176
    v_add_u32 v94, 1056, v93
    ds_read_b64_tr_b16 v[136:137], v254 offset:30784
    ds_read_b64_tr_b16 v[138:139], v254 offset:31552
    s_waitcnt lgkmcnt(13)
    v_mfma_f32_32x32x16_bf16 v[52:67], v[152:155], a[152:155], v[52:67]
    ds_read_b64_tr_b16 v[140:141], v254 offset:30848
    ds_read_b64_tr_b16 v[142:143], v254 offset:31616
    s_waitcnt vmcnt(15) lgkmcnt(12)
    v_mfma_f32_32x32x16_bf16 v[20:35], v[120:123], a[156:159], v[20:35]
    s_add_u32 s12, s8, s97
    ds_read_b64_tr_b16 v[144:145], v254 offset:33792
    ds_read_b64_tr_b16 v[146:147], v254 offset:34560
    s_waitcnt lgkmcnt(12)
    v_mfma_f32_32x32x16_bf16 v[36:51], v[124:127], a[156:159], v[36:51]
    s_add_u32 m0, s70, 0
    s_nop 0
    buffer_load_dwordx4 v241, s[52:55], s71 offen lds
    s_mul_i32 s12, s12, 8192
    ds_read_b64_tr_b16 v[148:149], v254 offset:33856
    ds_read_b64_tr_b16 v[150:151], v254 offset:34624
    buffer_load_dwordx4 a[196:199], v252, s[60:63], s77 offen offset:3072 sc1
    s_waitcnt lgkmcnt(11)
    v_mfma_f32_32x32x16_bf16 v[52:67], v[128:131], a[156:159], v[52:67]
    ds_read_b64_tr_b16 v[152:153], v254 offset:33920
    ds_read_b64_tr_b16 v[154:155], v254 offset:34688
    s_waitcnt vmcnt(15) lgkmcnt(11)
    v_mfma_f32_32x32x16_bf16 v[20:35], v[132:135], a[160:163], v[20:35]
    s_lshl_b32 s13, s99, 11
    v_lshlrev_b32 v188, 16, v68
    v_and_b32 v189, 0xffff0000, v68
    ds_read_b64_tr_b16 v[120:121], v254 offset:36864
    ds_read_b64_tr_b16 v[122:123], v254 offset:37632
    s_add_u32 s77, s80, 4
    s_and_b32 s77, s77, 7
    s_mul_i32 s77, s77, 5120
    s_add_u32 s77, s77, s76
    buffer_load_dwordx4 a[200:203], v253, s[60:63], s77 offen offset:0 sc1
    s_waitcnt lgkmcnt(10)
    v_mfma_f32_32x32x16_bf16 v[36:51], v[136:139], a[160:163], v[36:51]
    s_sub_u32 s12, s12, s13
    v_lshlrev_b32 v190, 16, v69
    ds_read_b64_tr_b16 v[124:125], v254 offset:36928
    ds_read_b64_tr_b16 v[126:127], v254 offset:37696
    s_waitcnt lgkmcnt(10)
    v_mfma_f32_32x32x16_bf16 v[52:67], v[140:143], a[160:163], v[52:67]
    s_add_u32 m0, s70, 1024
    s_nop 0
    buffer_load_dwordx4 v242, s[52:55], s71 offen lds
    v_and_b32 v191, 0xffff0000, v69
    v_lshlrev_b32 v192, 16, v70
    ds_read_b64_tr_b16 v[128:129], v254 offset:36992
    ds_read_b64_tr_b16 v[130:131], v254 offset:37760
    s_waitcnt vmcnt(16) lgkmcnt(10)
    v_mfma_f32_32x32x16_bf16 v[20:35], v[144:147], a[164:167], v[20:35]
    s_add_u32 s74, s12, 16779264
    v_and_b32 v193, 0xffff0000, v70
    ds_read_b64_tr_b16 v[132:133], v254 offset:39936
    ds_read_b64_tr_b16 v[134:135], v254 offset:40704
    s_waitcnt lgkmcnt(10)
    v_mfma_f32_32x32x16_bf16 v[36:51], v[148:151], a[164:167], v[36:51]
    s_nop 0
    v_lshlrev_b32 v194, 16, v71
    v_and_b32 v195, 0xffff0000, v71
    ds_read_b64_tr_b16 v[136:137], v254 offset:40000
    ds_read_b64_tr_b16 v[138:139], v254 offset:40768
    buffer_load_dwordx4 a[204:207], v253, s[60:63], s77 offen offset:1024 sc1
    s_waitcnt lgkmcnt(10)
    v_mfma_f32_32x32x16_bf16 v[52:67], v[152:155], a[164:167], v[52:67]
    v_lshlrev_b32 v196, 16, v72
    ds_read_b64_tr_b16 v[140:141], v254 offset:40064
    ds_read_b64_tr_b16 v[142:143], v254 offset:40832
    s_waitcnt vmcnt(15) lgkmcnt(10)
    v_mfma_f32_32x32x16_bf16 v[20:35], v[120:123], a[168:171], v[20:35]
    s_add_u32 m0, s70, 2048
    s_nop 0
    buffer_load_dwordx4 v243, s[52:55], s71 offen lds
    v_and_b32 v197, 0xffff0000, v72
    v_lshlrev_b32 v198, 16, v73
    ds_read_b64_tr_b16 v[144:145], v254 offset:43008
    ds_read_b64_tr_b16 v[146:147], v254 offset:43776
    buffer_load_dwordx4 a[208:211], v253, s[60:63], s77 offen offset:2048 sc1
    s_waitcnt lgkmcnt(10)
    v_mfma_f32_32x32x16_bf16 v[36:51], v[124:127], a[168:171], v[36:51]
    v_and_b32 v199, 0xffff0000, v73
    ds_read_b64_tr_b16 v[148:149], v254 offset:43072
    ds_read_b64_tr_b16 v[150:151], v254 offset:43840
    s_waitcnt lgkmcnt(10)
    v_mfma_f32_32x32x16_bf16 v[52:67], v[128:131], a[168:171], v[52:67]
    v_lshlrev_b32 v200, 16, v74
    v_and_b32 v201, 0xffff0000, v74
    ds_read_b64_tr_b16 v[152:153], v254 offset:43136
    ds_read_b64_tr_b16 v[154:155], v254 offset:43904
    s_waitcnt vmcnt(16) lgkmcnt(10)
    v_mfma_f32_32x32x16_bf16 v[20:35], v[132:135], a[172:175], v[20:35]
    v_lshlrev_b32 v202, 16, v75
    ds_read_b64_tr_b16 v[120:121], v254 offset:46080
    ds_read_b64_tr_b16 v[122:123], v254 offset:46848
    s_waitcnt lgkmcnt(10)
    v_mfma_f32_32x32x16_bf16 v[36:51], v[136:139], a[172:175], v[36:51]
    v_and_b32 v203, 0xffff0000, v75
    ds_read_b64_tr_b16 v[124:125], v254 offset:46144
    ds_read_b64_tr_b16 v[126:127], v254 offset:46912
    buffer_load_dwordx4 a[212:215], v253, s[60:63], s77 offen offset:3072 sc1
    s_waitcnt lgkmcnt(10)
    v_mfma_f32_32x32x16_bf16 v[52:67], v[140:143], a[172:175], v[52:67]
    v_lshlrev_b32 v204, 16, v76
    v_and_b32 v205, 0xffff0000, v76
    ds_read_b64_tr_b16 v[128:129], v254 offset:46208
    ds_read_b64_tr_b16 v[130:131], v254 offset:46976
    s_waitcnt vmcnt(15) lgkmcnt(10)
    v_mfma_f32_32x32x16_bf16 v[20:35], v[144:147], a[176:179], v[20:35]
    v_lshlrev_b32 v206, 16, v77
    ds_read_b64_tr_b16 v[132:133], v254 offset:49152
    ds_read_b64_tr_b16 v[134:135], v254 offset:49920
    buffer_load_dwordx4 a[216:219], v252, s[60:63], s77 offen offset:3072 sc1
    s_waitcnt lgkmcnt(10)
    v_mfma_f32_32x32x16_bf16 v[36:51], v[148:151], a[176:179], v[36:51]
    v_and_b32 v207, 0xffff0000, v77
    v_lshlrev_b32 v208, 16, v78
    ds_read_b64_tr_b16 v[136:137], v254 offset:49216
    ds_read_b64_tr_b16 v[138:139], v254 offset:49984
    s_waitcnt lgkmcnt(10)
    v_mfma_f32_32x32x16_bf16 v[52:67], v[152:155], a[176:179], v[52:67]
    v_and_b32 v209, 0xffff0000, v78
    ds_read_b64_tr_b16 v[140:141], v254 offset:49280
    ds_read_b64_tr_b16 v[142:143], v254 offset:50048
    s_waitcnt vmcnt(14) lgkmcnt(10)
    v_mfma_f32_32x32x16_bf16 v[20:35], v[120:123], a[180:183], v[20:35]
    v_lshlrev_b32 v210, 16, v79
    v_and_b32 v211, 0xffff0000, v79
    ds_read_b64_tr_b16 v[144:145], v254 offset:52224
    ds_read_b64_tr_b16 v[146:147], v254 offset:52992
    s_waitcnt lgkmcnt(10)
    v_mfma_f32_32x32x16_bf16 v[36:51], v[124:127], a[180:183], v[36:51]
    v_lshlrev_b32 v212, 16, v80
    ds_read_b64_tr_b16 v[148:149], v254 offset:52288
    ds_read_b64_tr_b16 v[150:151], v254 offset:53056
    s_add_u32 s77, s80, 5
    s_and_b32 s77, s77, 7
    s_mul_i32 s77, s77, 5120
    s_add_u32 s77, s77, s76
    buffer_load_dwordx4 a[220:223], v253, s[60:63], s77 offen offset:0 sc1
    s_waitcnt lgkmcnt(10)
    v_mfma_f32_32x32x16_bf16 v[52:67], v[128:131], a[180:183], v[52:67]
    v_and_b32 v213, 0xffff0000, v80
    v_lshlrev_b32 v214, 16, v81
    ds_read_b64_tr_b16 v[152:153], v254 offset:52352
    ds_read_b64_tr_b16 v[154:155], v254 offset:53120
    s_waitcnt vmcnt(14) lgkmcnt(10)
    v_mfma_f32_32x32x16_bf16 v[20:35], v[132:135], a[184:187], v[20:35]
    s_cmp_lg_u32 s3, 3
    s_cbranch_scc1 .Lnouf
    s_nop 0
    buffer_load_dwordx4 v[156:159], v249, s[60:63], 0 offen sc0 sc1
.Lnouf:
    v_and_b32 v215, 0xffff0000, v81
    ds_read_b64_tr_b16 v[120:121], v254 offset:55296
    ds_read_b64_tr_b16 v[122:123], v254 offset:56064
    buffer_load_dwordx4 a[224:227], v253, s[60:63], s77 offen offset:1024 sc1
    s_waitcnt lgkmcnt(10)
    v_mfma_f32_32x32x16_bf16 v[36:51], v[136:139], a[184:187], v[36:51]
    v_lshlrev_b32 v216, 16, v82
    v_and_b32 v217, 0xffff0000, v82
    ds_read_b64_tr_b16 v[124:125], v254 offset:55360
    ds_read_b64_tr_b16 v[126:127], v254 offset:56128
    s_waitcnt lgkmcnt(10)
    v_mfma_f32_32x32x16_bf16 v[52:67], v[140:143], a[184:187], v[52:67]
    v_lshlrev_b32 v218, 16, v83
    ds_read_b64_tr_b16 v[128:129], v254 offset:55424
    ds_read_b64_tr_b16 v[130:131], v254 offset:56192
    s_waitcnt vmcnt(13) lgkmcnt(10)
    v_mfma_f32_32x32x16_bf16 v[20:35], v[144:147], a[188:191], v[20:35]
    v_and_b32 v219, 0xffff0000, v83
    ds_read_b64_tr_b16 v[132:133], v254 offset:58368
    ds_read_b64_tr_b16 v[134:135], v254 offset:59136
    s_waitcnt lgkmcnt(10)
    v_mfma_f32_32x32x16_bf16 v[36:51], v[148:151], a[188:191], v[36:51]
    v_lshlrev_b32 v220, 16, v84
    v_and_b32 v221, 0xffff0000, v84
    ds_read_b64_tr_b16 v[136:137], v254 offset:58432
    ds_read_b64_tr_b16 v[138:139], v254 offset:59200
    buffer_load_dwordx4 a[228:231], v253, s[60:63], s77 offen offset:2048 sc1
    s_waitcnt lgkmcnt(10)
    v_mfma_f32_32x32x16_bf16 v[52:67], v[152:155], a[188:191], v[52:67]
    v_lshlrev_b32 v222, 16, v85
    ds_read_b64_tr_b16 v[140:141], v254 offset:58496
    ds_read_b64_tr_b16 v[142:143], v254 offset:59264
    s_waitcnt vmcnt(12) lgkmcnt(10)
    v_mfma_f32_32x32x16_bf16 v[20:35], v[120:123], a[192:195], v[20:35]
    v_and_b32 v223, 0xffff0000, v85
    v_lshlrev_b32 v224, 16, v86
    ds_read_b64_tr_b16 v[144:145], v255 offset:0
    ds_read_b64_tr_b16 v[146:147], v255 offset:768
    buffer_load_dwordx4 a[232:235], v253, s[60:63], s77 offen offset:3072 sc1
    s_waitcnt lgkmcnt(10)
    v_mfma_f32_32x32x16_bf16 v[36:51], v[124:127], a[192:195], v[36:51]
    v_and_b32 v225, 0xffff0000, v86
    ds_read_b64_tr_b16 v[148:149], v255 offset:64
    ds_read_b64_tr_b16 v[150:151], v255 offset:832
    s_waitcnt lgkmcnt(10)
    v_mfma_f32_32x32x16_bf16 v[52:67], v[128:131], a[192:195], v[52:67]
    v_lshlrev_b32 v226, 16, v87
    v_and_b32 v227, 0xffff0000, v87
    ds_read_b64_tr_b16 v[152:153], v255 offset:128
    ds_read_b64_tr_b16 v[154:155], v255 offset:896
    s_waitcnt vmcnt(11) lgkmcnt(10)
    v_mfma_f32_32x32x16_bf16 v[20:35], v[132:135], a[196:199], v[20:35]
    v_lshlrev_b32 v228, 16, v88
    ds_read_b64_tr_b16 v[120:121], v255 offset:3072
    ds_read_b64_tr_b16 v[122:123], v255 offset:3840
    s_waitcnt lgkmcnt(10)
    v_mfma_f32_32x32x16_bf16 v[36:51], v[136:139], a[196:199], v[36:51]
    v_and_b32 v229, 0xffff0000, v88
    v_lshlrev_b32 v230, 16, v89
    ds_read_b64_tr_b16 v[124:125], v255 offset:3136
    ds_read_b64_tr_b16 v[126:127], v255 offset:3904
    buffer_load_dwordx4 a[236:239], v252, s[60:63], s77 offen offset:3072 sc1
    s_waitcnt lgkmcnt(10)
    v_mfma_f32_32x32x16_bf16 v[52:67], v[140:143], a[196:199], v[52:67]
    v_and_b32 v231, 0xffff0000, v89
    ds_read_b64_tr_b16 v[128:129], v255 offset:3200
    ds_read_b64_tr_b16 v[130:131], v255 offset:3968
    s_waitcnt vmcnt(11) lgkmcnt(10)
    v_mfma_f32_32x32x16_bf16 v[20:35], v[144:147], a[200:203], v[20:35]
    v_lshlrev_b32 v232, 16, v90
    v_and_b32 v233, 0xffff0000, v90
    ds_read_b64_tr_b16 v[132:133], v255 offset:6144
    ds_read_b64_tr_b16 v[134:135], v255 offset:6912
    s_add_u32 s77, s80, 6
    s_and_b32 s77, s77, 7
    s_mul_i32 s77, s77, 5120
    s_add_u32 s77, s77, s76
    buffer_load_dwordx4 a[120:123], v253, s[60:63], s77 offen offset:0 sc1
    s_waitcnt lgkmcnt(10)
    v_mfma_f32_32x32x16_bf16 v[36:51], v[148:151], a[200:203], v[36:51]
    v_lshlrev_b32 v234, 16, v91
    ds_read_b64_tr_b16 v[136:137], v255 offset:6208
    ds_read_b64_tr_b16 v[138:139], v255 offset:6976
    s_waitcnt lgkmcnt(10)
    v_mfma_f32_32x32x16_bf16 v[52:67], v[152:155], a[200:203], v[52:67]
    v_and_b32 v235, 0xffff0000, v91
    ds_read_b64_tr_b16 v[140:141], v255 offset:6272
    ds_read_b64_tr_b16 v[142:143], v255 offset:7040
    s_waitcnt vmcnt(10) lgkmcnt(10)
    v_mfma_f32_32x32x16_bf16 v[20:35], v[120:123], a[204:207], v[20:35]
    ds_read_b64_tr_b16 v[144:145], v255 offset:9216
    ds_read_b64_tr_b16 v[146:147], v255 offset:9984
    s_waitcnt lgkmcnt(10)
    s_nop 0
    v_mfma_f32_32x32x16_bf16 v[36:51], v[124:127], a[204:207], v[36:51]
    ds_read_b64 v[78:79], v244 offset:0
    ds_read_b64_tr_b16 v[148:149], v255 offset:9280
    ds_read_b64_tr_b16 v[150:151], v255 offset:10048
    buffer_load_dwordx4 a[124:127], v253, s[60:63], s77 offen offset:1024 sc1
    s_waitcnt lgkmcnt(11)
    v_mfma_f32_32x32x16_bf16 v[52:67], v[128:131], a[204:207], v[52:67]
    ds_read_b64_tr_b16 v[152:153], v255 offset:9344
    ds_read_b64_tr_b16 v[154:155], v255 offset:10112
    s_waitcnt vmcnt(9) lgkmcnt(11)
    v_mfma_f32_32x32x16_bf16 v[20:35], v[132:135], a[208:211], v[20:35]
    ds_read_b64 v[68:69], v244 offset:256
    ds_read_b64_tr_b16 v[120:121], v255 offset:12288
    ds_read_b64_tr_b16 v[122:123], v255 offset:13056
    buffer_load_dwordx4 a[128:131], v253, s[60:63], s77 offen offset:2048 sc1
    s_waitcnt lgkmcnt(12)
    v_mfma_f32_32x32x16_bf16 v[36:51], v[136:139], a[208:211], v[36:51]
    ds_read_b64_tr_b16 v[124:125], v255 offset:12352
    ds_read_b64_tr_b16 v[126:127], v255 offset:13120
    s_waitcnt lgkmcnt(12)
    v_mfma_f32_32x32x16_bf16 v[52:67], v[140:143], a[208:211], v[52:67]
    ds_read_b64 v[80:81], v244 offset:32
    ds_read_b64_tr_b16 v[128:129], v255 offset:12416
    ds_read_b64_tr_b16 v[130:131], v255 offset:13184
    s_waitcnt vmcnt(9) lgkmcnt(13)
    v_mfma_f32_32x32x16_bf16 v[20:35], v[144:147], a[212:215], v[20:35]
    ds_read_b64_tr_b16 v[132:133], v255 offset:15360
    ds_read_b64_tr_b16 v[134:135], v255 offset:16128
    s_waitcnt lgkmcnt(12)
    v_mfma_f32_32x32x16_bf16 v[36:51], v[148:151], a[212:215], v[36:51]
    v_mov_b32 v241, s10
    v_mov_b32 v242, 0
    ds_read_b64 v[70:71], v244 offset:288
    ds_read_b64_tr_b16 v[136:137], v255 offset:15424
    ds_read_b64_tr_b16 v[138:139], v255 offset:16192
    buffer_load_dwordx4 a[132:135], v253, s[60:63], s77 offen offset:3072 sc1
    s_waitcnt lgkmcnt(13)
    v_mfma_f32_32x32x16_bf16 v[52:67], v[152:155], a[212:215], v[52:67]
    ds_read_b64_tr_b16 v[140:141], v255 offset:15488
    ds_read_b64_tr_b16 v[142:143], v255 offset:16256
    s_waitcnt vmcnt(9) lgkmcnt(12)
    v_mfma_f32_32x32x16_bf16 v[20:35], v[120:123], a[216:219], v[20:35]
    ds_read_b64 v[82:83], v244 offset:64
    ds_read_b64_tr_b16 v[144:145], v255 offset:18432
    ds_read_b64_tr_b16 v[146:147], v255 offset:19200
    buffer_load_dwordx4 a[136:139], v252, s[60:63], s77 offen offset:3072 sc1
    s_waitcnt lgkmcnt(13)
    v_mfma_f32_32x32x16_bf16 v[36:51], v[124:127], a[216:219], v[36:51]
    ds_read_b64_tr_b16 v[148:149], v255 offset:18496
    ds_read_b64_tr_b16 v[150:151], v255 offset:19264
    s_waitcnt lgkmcnt(12)
    v_mfma_f32_32x32x16_bf16 v[52:67], v[128:131], a[216:219], v[52:67]
    ds_read_b64 v[72:73], v244 offset:320
    ds_read_b64_tr_b16 v[152:153], v255 offset:18560
    ds_read_b64_tr_b16 v[154:155], v255 offset:19328
    s_waitcnt vmcnt(9) lgkmcnt(13)
    v_mfma_f32_32x32x16_bf16 v[20:35], v[132:135], a[220:223], v[20:35]
    ds_read_b64_tr_b16 v[120:121], v255 offset:21504
    ds_read_b64_tr_b16 v[122:123], v255 offset:22272
    s_waitcnt lgkmcnt(12)
    v_mfma_f32_32x32x16_bf16 v[36:51], v[136:139], a[220:223], v[36:51]
    ds_read_b64 v[84:85], v244 offset:96
    ds_read_b64_tr_b16 v[124:125], v255 offset:21568
    ds_read_b64_tr_b16 v[126:127], v255 offset:22336
    s_add_u32 s77, s80, 7
    s_and_b32 s77, s77, 7
    s_mul_i32 s77, s77, 5120
    s_add_u32 s77, s77, s76
    buffer_load_dwordx4 a[140:143], v253, s[60:63], s77 offen offset:0 sc1
    s_waitcnt lgkmcnt(13)
    v_mfma_f32_32x32x16_bf16 v[52:67], v[140:143], a[220:223], v[52:67]
    ds_read_b64_tr_b16 v[128:129], v255 offset:21632
    ds_read_b64_tr_b16 v[130:131], v255 offset:22400
    s_cmp_lg_u32 s3, 3
    s_cbranch_scc1 .Lnouc
    s_waitcnt vmcnt(10)
    v_xor_b32 v156, s10, v156
    v_xor_b32 v157, s10, v157
    v_xor_b32 v158, s10, v158
    v_xor_b32 v159, s10, v159
    v_or_b32 v156, v156, v157
    v_or_b32 v156, v156, v158
    v_or_b32 v156, v156, v159
    v_cmp_ne_u32 vcc, 0, v156
    s_nop 0
    s_cbranch_vccnz .Lc6s
.Lc6b:
.Lnouc:
    s_barrier
    s_mov_b32 exec_lo, 0x77777777
    s_mov_b32 exec_hi, 0x77777777
    buffer_load_dwordx4 v[160:163], v105, s[60:63], s85 offen sc1
    s_add_u32 s85, s85, 262144
    buffer_load_dwordx4 v[164:167], v105, s[60:63], s85 offen sc1
    s_add_u32 s85, s85, 262144
    buffer_load_dwordx4 v[168:171], v105, s[60:63], s85 offen sc1
    s_add_u32 s85, s85, 262144
    buffer_load_dwordx4 v[172:175], v105, s[60:63], s85 offen sc1
    s_mov_b64 exec, -1
    s_waitcnt vmcnt(13) lgkmcnt(12)
    v_mfma_f32_32x32x16_bf16 v[20:35], v[144:147], a[224:227], v[20:35]
    ds_read_b64 v[74:75], v244 offset:352
    ds_read_b64_tr_b16 v[132:133], v255 offset:24576
    ds_read_b64_tr_b16 v[134:135], v255 offset:25344
    buffer_load_dwordx4 a[144:147], v253, s[60:63], s77 offen offset:1024 sc1
    s_waitcnt lgkmcnt(13)
    v_mfma_f32_32x32x16_bf16 v[36:51], v[148:151], a[224:227], v[36:51]
    ds_read_b64_tr_b16 v[136:137], v255 offset:24640
    ds_read_b64_tr_b16 v[138:139], v255 offset:25408
    s_waitcnt lgkmcnt(12)
    v_mfma_f32_32x32x16_bf16 v[52:67], v[152:155], a[224:227], v[52:67]
    ds_read_b64 v[86:87], v244 offset:128
    ds_read_b64_tr_b16 v[140:141], v255 offset:24704
    ds_read_b64_tr_b16 v[142:143], v255 offset:25472
    s_waitcnt vmcnt(13) lgkmcnt(13)
    v_mfma_f32_32x32x16_bf16 v[20:35], v[120:123], a[228:231], v[20:35]
    ds_read_b64_tr_b16 v[144:145], v255 offset:27648
    ds_read_b64_tr_b16 v[146:147], v255 offset:28416
    s_waitcnt lgkmcnt(12)
    v_mfma_f32_32x32x16_bf16 v[36:51], v[124:127], a[228:231], v[36:51]
    ds_read_b64 v[76:77], v244 offset:384
    ds_read_b64_tr_b16 v[148:149], v255 offset:27712
    ds_read_b64_tr_b16 v[150:151], v255 offset:28480
    buffer_load_dwordx4 a[148:151], v253, s[60:63], s77 offen offset:2048 sc1
    s_waitcnt lgkmcnt(13)
    v_mfma_f32_32x32x16_bf16 v[52:67], v[128:131], a[228:231], v[52:67]
    ds_read_b64_tr_b16 v[152:153], v255 offset:27776
    ds_read_b64_tr_b16 v[154:155], v255 offset:28544
    s_waitcnt vmcnt(13) lgkmcnt(12)
    v_mfma_f32_32x32x16_bf16 v[20:35], v[132:135], a[232:235], v[20:35]
    s_add_u32 s81, s81, 40960
    ds_read_b64_tr_b16 v[120:121], v255 offset:30720
    ds_read_b64_tr_b16 v[122:123], v255 offset:31488
    buffer_load_dwordx4 a[152:155], v253, s[60:63], s77 offen offset:3072 sc1
    s_waitcnt lgkmcnt(12)
    v_mfma_f32_32x32x16_bf16 v[36:51], v[136:139], a[232:235], v[36:51]
    ds_read_b64_tr_b16 v[124:125], v255 offset:30784
    ds_read_b64_tr_b16 v[126:127], v255 offset:31552
    s_waitcnt lgkmcnt(11)
    v_mfma_f32_32x32x16_bf16 v[52:67], v[140:143], a[232:235], v[52:67]
    buffer_load_dwordx4 a[0:3], v253, s[60:63], s81 offen offset:0 sc1
    ds_read_b64_tr_b16 v[128:129], v255 offset:30848
    ds_read_b64_tr_b16 v[130:131], v255 offset:31616
    s_waitcnt vmcnt(14) lgkmcnt(11)
    v_mfma_f32_32x32x16_bf16 v[20:35], v[144:147], a[236:239], v[20:35]
    ds_read_b64_tr_b16 v[132:133], v255 offset:33792
    ds_read_b64_tr_b16 v[134:135], v255 offset:34560
    s_waitcnt lgkmcnt(10)
    v_mfma_f32_32x32x16_bf16 v[36:51], v[148:151], a[236:239], v[36:51]
    buffer_load_dwordx4 a[4:7], v253, s[60:63], s81 offen offset:1024 sc1
    ds_read_b64_tr_b16 v[136:137], v255 offset:33856
    ds_read_b64_tr_b16 v[138:139], v255 offset:34624
    buffer_load_dwordx4 a[156:159], v252, s[60:63], s77 offen offset:3072 sc1
    s_waitcnt lgkmcnt(10)
    v_mfma_f32_32x32x16_bf16 v[52:67], v[152:155], a[236:239], v[52:67]
    ds_read_b64_tr_b16 v[140:141], v255 offset:33920
    ds_read_b64_tr_b16 v[142:143], v255 offset:34688
    s_waitcnt vmcnt(15) lgkmcnt(10)
    v_mfma_f32_32x32x16_bf16 v[20:35], v[120:123], a[120:123], v[20:35]
    ds_read_b64_tr_b16 v[144:145], v255 offset:36864
    ds_read_b64_tr_b16 v[146:147], v255 offset:37632
    s_waitcnt lgkmcnt(10)
    v_mfma_f32_32x32x16_bf16 v[36:51], v[124:127], a[120:123], v[36:51]
    buffer_load_dwordx4 a[8:11], v253, s[60:63], s81 offen offset:2048 sc1
    ds_read_b64_tr_b16 v[148:149], v255 offset:36928
    ds_read_b64_tr_b16 v[150:151], v255 offset:37696
    s_waitcnt lgkmcnt(10)
    v_mfma_f32_32x32x16_bf16 v[52:67], v[128:131], a[120:123], v[52:67]
    ds_read_b64_tr_b16 v[152:153], v255 offset:36992
    ds_read_b64_tr_b16 v[154:155], v255 offset:37760
    s_waitcnt vmcnt(15) lgkmcnt(10)
    v_mfma_f32_32x32x16_bf16 v[20:35], v[132:135], a[124:127], v[20:35]
    buffer_load_dwordx4 a[12:15], v253, s[60:63], s81 offen offset:3072 sc1
    ds_read_b64_tr_b16 v[120:121], v255 offset:39936
    ds_read_b64_tr_b16 v[122:123], v255 offset:40704
    s_waitcnt lgkmcnt(10)
    v_mfma_f32_32x32x16_bf16 v[36:51], v[136:139], a[124:127], v[36:51]
    ds_read_b64_tr_b16 v[124:125], v255 offset:40000
    ds_read_b64_tr_b16 v[126:127], v255 offset:40768
    s_waitcnt lgkmcnt(10)
    v_mfma_f32_32x32x16_bf16 v[52:67], v[140:143], a[124:127], v[52:67]
    ds_read_b64_tr_b16 v[128:129], v255 offset:40064
    ds_read_b64_tr_b16 v[130:131], v255 offset:40832
    s_waitcnt vmcnt(15) lgkmcnt(10)
    v_mfma_f32_32x32x16_bf16 v[20:35], v[144:147], a[128:131], v[20:35]
    buffer_load_dwordx4 a[16:19], v252, s[60:63], s81 offen offset:3072 sc1
    ds_read_b64_tr_b16 v[132:133], v255 offset:43008
    ds_read_b64_tr_b16 v[134:135], v255 offset:43776
    s_waitcnt lgkmcnt(10)
    v_mfma_f32_32x32x16_bf16 v[36:51], v[148:151], a[128:131], v[36:51]
    ds_read_b64_tr_b16 v[136:137], v255 offset:43072
    ds_read_b64_tr_b16 v[138:139], v255 offset:43840
    s_waitcnt lgkmcnt(10)
    v_mfma_f32_32x32x16_bf16 v[52:67], v[152:155], a[128:131], v[52:67]
    s_add_u32 s81, s81, 40960
    ds_read_b64_tr_b16 v[140:141], v255 offset:43136
    ds_read_b64_tr_b16 v[142:143], v255 offset:43904
    s_waitcnt vmcnt(15) lgkmcnt(10)
    v_mfma_f32_32x32x16_bf16 v[20:35], v[120:123], a[132:135], v[20:35]
    ds_read_b64_tr_b16 v[144:145], v255 offset:46080
    ds_read_b64_tr_b16 v[146:147], v255 offset:46848
    s_waitcnt lgkmcnt(10)
    v_mfma_f32_32x32x16_bf16 v[36:51], v[124:127], a[132:135], v[36:51]
    buffer_load_dwordx4 a[20:23], v253, s[60:63], s81 offen offset:0 sc1
    ds_read_b64_tr_b16 v[148:149], v255 offset:46144
    ds_read_b64_tr_b16 v[150:151], v255 offset:46912
    s_waitcnt lgkmcnt(10)
    v_mfma_f32_32x32x16_bf16 v[52:67], v[128:131], a[132:135], v[52:67]
    ds_read_b64_tr_b16 v[152:153], v255 offset:46208
    ds_read_b64_tr_b16 v[154:155], v255 offset:46976
    s_waitcnt vmcnt(15) lgkmcnt(10)
    v_mfma_f32_32x32x16_bf16 v[20:35], v[132:135], a[136:139], v[20:35]
    ds_read_b64_tr_b16 v[120:121], v255 offset:49152
    ds_read_b64_tr_b16 v[122:123], v255 offset:49920
    s_waitcnt lgkmcnt(10)
    v_mfma_f32_32x32x16_bf16 v[36:51], v[136:139], a[136:139], v[36:51]
    buffer_load_dwordx4 a[24:27], v253, s[60:63], s81 offen offset:1024 sc1
    ds_read_b64_tr_b16 v[124:125], v255 offset:49216
    ds_read_b64_tr_b16 v[126:127], v255 offset:49984
    s_waitcnt lgkmcnt(10)
    v_mfma_f32_32x32x16_bf16 v[52:67], v[140:143], a[136:139], v[52:67]
    ds_read_b64_tr_b16 v[128:129], v255 offset:49280
    ds_read_b64_tr_b16 v[130:131], v255 offset:50048
    s_waitcnt vmcnt(15) lgkmcnt(10)
    v_mfma_f32_32x32x16_bf16 v[20:35], v[144:147], a[140:143], v[20:35]
    buffer_load_dwordx4 a[28:31], v253, s[60:63], s81 offen offset:2048 sc1
    ds_read_b64_tr_b16 v[132:133], v255 offset:52224
    ds_read_b64_tr_b16 v[134:135], v255 offset:52992
    s_waitcnt lgkmcnt(10)
    v_mfma_f32_32x32x16_bf16 v[36:51], v[148:151], a[140:143], v[36:51]
    ds_read_b64_tr_b16 v[136:137], v255 offset:52288
    ds_read_b64_tr_b16 v[138:139], v255 offset:53056
    s_waitcnt lgkmcnt(10)
    v_mfma_f32_32x32x16_bf16 v[52:67], v[152:155], a[140:143], v[52:67]
    ds_read_b64_tr_b16 v[140:141], v255 offset:52352
    ds_read_b64_tr_b16 v[142:143], v255 offset:53120
    s_waitcnt vmcnt(11) lgkmcnt(10)
    v_mfma_f32_32x32x16_bf16 v[20:35], v[120:123], a[144:147], v[20:35]
    buffer_load_dwordx4 a[32:35], v253, s[60:63], s81 offen offset:3072 sc1
    ds_read_b64_tr_b16 v[144:145], v255 offset:55296
    ds_read_b64_tr_b16 v[146:147], v255 offset:56064
    s_waitcnt lgkmcnt(10)
    v_mfma_f32_32x32x16_bf16 v[36:51], v[124:127], a[144:147], v[36:51]
    ds_read_b64_tr_b16 v[148:149], v255 offset:55360
    ds_read_b64_tr_b16 v[150:151], v255 offset:56128
    s_waitcnt lgkmcnt(10)
    v_mfma_f32_32x32x16_bf16 v[52:67], v[128:131], a[144:147], v[52:67]
    buffer_load_dwordx4 a[36:39], v252, s[60:63], s81 offen offset:3072 sc1
    ds_read_b64_tr_b16 v[152:153], v255 offset:55424
    ds_read_b64_tr_b16 v[154:155], v255 offset:56192
    s_waitcnt vmcnt(12) lgkmcnt(10)
    v_mfma_f32_32x32x16_bf16 v[20:35], v[132:135], a[148:151], v[20:35]
    ds_read_b64_tr_b16 v[120:121], v255 offset:58368
    ds_read_b64_tr_b16 v[122:123], v255 offset:59136
    s_waitcnt lgkmcnt(10)
    v_mfma_f32_32x32x16_bf16 v[36:51], v[136:139], a[148:151], v[36:51]
    s_add_u32 s81, s81, 40960
    ds_read_b64_tr_b16 v[124:125], v255 offset:58432
    ds_read_b64_tr_b16 v[126:127], v255 offset:59200
    s_waitcnt lgkmcnt(10)
    v_mfma_f32_32x32x16_bf16 v[52:67], v[140:143], a[148:151], v[52:67]
    ds_read_b64_tr_b16 v[128:129], v255 offset:58496
    ds_read_b64_tr_b16 v[130:131], v255 offset:59264
    s_waitcnt vmcnt(11) lgkmcnt(10)
    v_mfma_f32_32x32x16_bf16 v[20:35], v[144:147], a[152:155], v[20:35]
    s_waitcnt lgkmcnt(8)
    v_mfma_f32_32x32x16_bf16 v[36:51], v[148:151], a[152:155], v[36:51]
    buffer_load_dwordx4 a[40:43], v253, s[60:63], s81 offen offset:0 sc1
    s_waitcnt lgkmcnt(6)
    v_mfma_f32_32x32x16_bf16 v[52:67], v[152:155], a[152:155], v[52:67]
    s_waitcnt vmcnt(9) lgkmcnt(4)
    v_mfma_f32_32x32x16_bf16 v[20:35], v[120:123], a[156:159], v[20:35]
    buffer_load_dwordx4 a[44:47], v253, s[60:63], s81 offen offset:1024 sc1
    s_waitcnt lgkmcnt(2)
    v_mfma_f32_32x32x16_bf16 v[36:51], v[124:127], a[156:159], v[36:51]
    s_waitcnt lgkmcnt(0)
    v_mfma_f32_32x32x16_bf16 v[52:67], v[128:131], a[156:159], v[52:67]
    s_nop 6
    v_cvt_pk_bf16_f32 v108, v20, v21
    v_dot2_f32_bf16 v20, v108, s72, v188
    v_dot2_f32_bf16 v21, v108, s73, v189
    v_cvt_pk_bf16_f32 v109, v22, v23
    v_dot2_f32_bf16 v22, v109, s72, v190
    v_dot2_f32_bf16 v23, v109, s73, v191
    v_cvt_pk_bf16_f32 v110, v24, v25
    v_dot2_f32_bf16 v24, v110, s72, v192
    v_dot2_f32_bf16 v25, v110, s73, v193
    v_cvt_pk_bf16_f32 v111, v26, v27
    v_dot2_f32_bf16 v26, v111, s72, v194
    v_dot2_f32_bf16 v27, v111, s73, v195
    v_cvt_pk_bf16_f32 v112, v28, v29
    v_dot2_f32_bf16 v28, v112, s72, v196
    buffer_load_dwordx4 a[48:51], v253, s[60:63], s81 offen offset:2048 sc1
    v_dot2_f32_bf16 v29, v112, s73, v197
    v_cvt_pk_bf16_f32 v113, v30, v31
    v_dot2_f32_bf16 v30, v113, s72, v198
    v_dot2_f32_bf16 v31, v113, s73, v199
    v_cvt_pk_bf16_f32 v114, v32, v33
    v_dot2_f32_bf16 v32, v114, s72, v200
    v_dot2_f32_bf16 v33, v114, s73, v201
    v_cvt_pk_bf16_f32 v115, v34, v35
    v_dot2_f32_bf16 v34, v115, s72, v202
    v_dot2_f32_bf16 v35, v115, s73, v203
    v_cvt_pk_bf16_f32 v108, v20, v21
    v_pk_max_i16 v108, v108, 0
    v_lshlrev_b32_e64 v20, 16, v108
    v_and_b32 v21, 0xffff0000, v108
    buffer_load_dwordx4 a[52:55], v253, s[60:63], s81 offen offset:3072 sc1
    v_pk_mul_f32 v[20:21], v[20:21], v[20:21]
    v_cvt_pk_bf16_f32 v108, v20, v21
    v_cvt_pk_bf16_f32 v109, v22, v23
    v_pk_max_i16 v109, v109, 0
    v_lshlrev_b32_e64 v22, 16, v109
    v_and_b32 v23, 0xffff0000, v109
    v_pk_mul_f32 v[22:23], v[22:23], v[22:23]
    v_cvt_pk_bf16_f32 v109, v22, v23
    v_cvt_pk_bf16_f32 v110, v24, v25
    v_pk_max_i16 v110, v110, 0
    v_lshlrev_b32_e64 v24, 16, v110
    v_and_b32 v25, 0xffff0000, v110
    v_pk_mul_f32 v[24:25], v[24:25], v[24:25]
    v_cvt_pk_bf16_f32 v110, v24, v25
    buffer_load_dwordx4 a[56:59], v252, s[60:63], s81 offen offset:3072 sc1
    v_cvt_pk_bf16_f32 v111, v26, v27
    v_pk_max_i16 v111, v111, 0
    v_lshlrev_b32_e64 v26, 16, v111
    v_and_b32 v27, 0xffff0000, v111
    v_pk_mul_f32 v[26:27], v[26:27], v[26:27]
    v_cvt_pk_bf16_f32 v111, v26, v27
    v_cvt_pk_bf16_f32 v112, v28, v29
    v_pk_max_i16 v112, v112, 0
    v_lshlrev_b32_e64 v28, 16, v112
    v_and_b32 v29, 0xffff0000, v112
    v_pk_mul_f32 v[28:29], v[28:29], v[28:29]
    v_cvt_pk_bf16_f32 v112, v28, v29
    v_cvt_pk_bf16_f32 v113, v30, v31
    v_pk_max_i16 v113, v113, 0
    s_add_u32 s81, s81, 40960
    buffer_load_dwordx4 a[60:63], v253, s[60:63], s81 offen offset:0 sc1
    v_lshlrev_b32_e64 v30, 16, v113
    v_and_b32 v31, 0xffff0000, v113
    v_pk_mul_f32 v[30:31], v[30:31], v[30:31]
    v_cvt_pk_bf16_f32 v113, v30, v31
    v_cvt_pk_bf16_f32 v114, v32, v33
    v_pk_max_i16 v114, v114, 0
    v_lshlrev_b32_e64 v32, 16, v114
    v_and_b32 v33, 0xffff0000, v114
    v_pk_mul_f32 v[32:33], v[32:33], v[32:33]
    v_cvt_pk_bf16_f32 v114, v32, v33
    v_cvt_pk_bf16_f32 v115, v34, v35
    v_pk_max_i16 v115, v115, 0
    v_lshlrev_b32_e64 v34, 16, v115
    v_and_b32 v35, 0xffff0000, v115
    v_pk_mul_f32 v[34:35], v[34:35], v[34:35]
    v_cvt_pk_bf16_f32 v115, v34, v35
    buffer_store_dwordx4 v[108:111], v246, s[60:63], s88 offen offset:0 sc0 sc1
    buffer_store_dwordx4 v[112:115], v246, s[60:63], s88 offen offset:512 sc0 sc1
    v_cvt_pk_bf16_f32 v116, v36, v37
    v_dot2_f32_bf16 v36, v116, s72, v204
    v_dot2_f32_bf16 v37, v116, s73, v205
    v_cvt_pk_bf16_f32 v117, v38, v39
    v_dot2_f32_bf16 v38, v117, s72, v206
    v_dot2_f32_bf16 v39, v117, s73, v207
    v_cvt_pk_bf16_f32 v118, v40, v41
    v_dot2_f32_bf16 v40, v118, s72, v208
    v_dot2_f32_bf16 v41, v118, s73, v209
    v_cvt_pk_bf16_f32 v119, v42, v43
    v_dot2_f32_bf16 v42, v119, s72, v210
    v_dot2_f32_bf16 v43, v119, s73, v211
    v_cvt_pk_bf16_f32 v120, v44, v45
    v_dot2_f32_bf16 v44, v120, s72, v212
    buffer_load_dwordx4 a[64:67], v253, s[60:63], s81 offen offset:1024 sc1
    v_dot2_f32_bf16 v45, v120, s73, v213
    v_cvt_pk_bf16_f32 v121, v46, v47
    v_dot2_f32_bf16 v46, v121, s72, v214
    v_dot2_f32_bf16 v47, v121, s73, v215
    v_cvt_pk_bf16_f32 v122, v48, v49
    v_dot2_f32_bf16 v48, v122, s72, v216
    v_dot2_f32_bf16 v49, v122, s73, v217
    v_cvt_pk_bf16_f32 v123, v50, v51
    v_dot2_f32_bf16 v50, v123, s72, v218
    v_dot2_f32_bf16 v51, v123, s73, v219
    v_cvt_pk_bf16_f32 v116, v36, v37
    v_pk_max_i16 v116, v116, 0
    v_lshlrev_b32_e64 v36, 16, v116
    v_and_b32 v37, 0xffff0000, v116
    buffer_load_dwordx4 a[68:71], v253, s[60:63], s81 offen offset:2048 sc1
    v_pk_mul_f32 v[36:37], v[36:37], v[36:37]
    v_cvt_pk_bf16_f32 v116, v36, v37
    v_cvt_pk_bf16_f32 v117, v38, v39
    v_pk_max_i16 v117, v117, 0
    v_lshlrev_b32_e64 v38, 16, v117
    v_and_b32 v39, 0xffff0000, v117
    v_pk_mul_f32 v[38:39], v[38:39], v[38:39]
    v_cvt_pk_bf16_f32 v117, v38, v39
    v_cvt_pk_bf16_f32 v118, v40, v41
    v_pk_max_i16 v118, v118, 0
    v_lshlrev_b32_e64 v40, 16, v118
    v_and_b32 v41, 0xffff0000, v118
    v_pk_mul_f32 v[40:41], v[40:41], v[40:41]
    v_cvt_pk_bf16_f32 v118, v40, v41
    buffer_load_dwordx4 a[72:75], v253, s[60:63], s81 offen offset:3072 sc1
    v_cvt_pk_bf16_f32 v119, v42, v43
    v_pk_max_i16 v119, v119, 0
    v_lshlrev_b32_e64 v42, 16, v119
    v_and_b32 v43, 0xffff0000, v119
    v_pk_mul_f32 v[42:43], v[42:43], v[42:43]
    v_cvt_pk_bf16_f32 v119, v42, v43
    v_cvt_pk_bf16_f32 v120, v44, v45
    v_pk_max_i16 v120, v120, 0
    v_lshlrev_b32_e64 v44, 16, v120
    v_and_b32 v45, 0xffff0000, v120
    v_pk_mul_f32 v[44:45], v[44:45], v[44:45]
    v_cvt_pk_bf16_f32 v120, v44, v45
    v_cvt_pk_bf16_f32 v121, v46, v47
    v_pk_max_i16 v121, v121, 0
    buffer_load_dwordx4 a[76:79], v252, s[60:63], s81 offen offset:3072 sc1
    v_lshlrev_b32_e64 v46, 16, v121
    v_and_b32 v47, 0xffff0000, v121
    v_pk_mul_f32 v[46:47], v[46:47], v[46:47]
    v_cvt_pk_bf16_f32 v121, v46, v47
    v_cvt_pk_bf16_f32 v122, v48, v49
    v_pk_max_i16 v122, v122, 0
    v_lshlrev_b32_e64 v48, 16, v122
    v_and_b32 v49, 0xffff0000, v122
    v_pk_mul_f32 v[48:49], v[48:49], v[48:49]
    v_cvt_pk_bf16_f32 v122, v48, v49
    v_cvt_pk_bf16_f32 v123, v50, v51
    v_pk_max_i16 v123, v123, 0
    v_lshlrev_b32_e64 v50, 16, v123
    v_and_b32 v51, 0xffff0000, v123
    v_pk_mul_f32 v[50:51], v[50:51], v[50:51]
    v_cvt_pk_bf16_f32 v123, v50, v51
    buffer_store_dwordx4 v[116:119], v246, s[60:63], s88 offen offset:1024 sc0 sc1
    buffer_store_dwordx4 v[120:123], v246, s[60:63], s88 offen offset:1536 sc0 sc1
    v_cvt_pk_bf16_f32 v124, v52, v53
    v_dot2_f32_bf16 v52, v124, s72, v220
    v_dot2_f32_bf16 v53, v124, s73, v221
    v_cvt_pk_bf16_f32 v125, v54, v55
    v_dot2_f32_bf16 v54, v125, s72, v222
    v_dot2_f32_bf16 v55, v125, s73, v223
    v_cvt_pk_bf16_f32 v126, v56, v57
    v_dot2_f32_bf16 v56, v126, s72, v224
    v_dot2_f32_bf16 v57, v126, s73, v225
    v_cvt_pk_bf16_f32 v127, v58, v59
    v_dot2_f32_bf16 v58, v127, s72, v226
    v_dot2_f32_bf16 v59, v127, s73, v227
    v_cvt_pk_bf16_f32 v128, v60, v61
    v_dot2_f32_bf16 v60, v128, s72, v228
    s_add_u32 s81, s81, 40960
    buffer_load_dwordx4 a[80:83], v253, s[60:63], s81 offen offset:0 sc1
    v_dot2_f32_bf16 v61, v128, s73, v229
    v_cvt_pk_bf16_f32 v129, v62, v63
    v_dot2_f32_bf16 v62, v129, s72, v230
    v_dot2_f32_bf16 v63, v129, s73, v231
    v_cvt_pk_bf16_f32 v130, v64, v65
    v_dot2_f32_bf16 v64, v130, s72, v232
    v_dot2_f32_bf16 v65, v130, s73, v233
    v_cvt_pk_bf16_f32 v131, v66, v67
    v_dot2_f32_bf16 v66, v131, s72, v234
    v_dot2_f32_bf16 v67, v131, s73, v235
    v_cvt_pk_bf16_f32 v124, v52, v53
    v_pk_max_i16 v124, v124, 0
    v_lshlrev_b32_e64 v52, 16, v124
    v_and_b32 v53, 0xffff0000, v124
    buffer_load_dwordx4 a[84:87], v253, s[60:63], s81 offen offset:1024 sc1
    v_pk_mul_f32 v[52:53], v[52:53], v[52:53]
    v_cvt_pk_bf16_f32 v124, v52, v53
    v_cvt_pk_bf16_f32 v125, v54, v55
    v_pk_max_i16 v125, v125, 0
    v_lshlrev_b32_e64 v54, 16, v125
    v_and_b32 v55, 0xffff0000, v125
    v_pk_mul_f32 v[54:55], v[54:55], v[54:55]
    v_cvt_pk_bf16_f32 v125, v54, v55
    v_cvt_pk_bf16_f32 v126, v56, v57
    v_pk_max_i16 v126, v126, 0
    v_lshlrev_b32_e64 v56, 16, v126
    v_and_b32 v57, 0xffff0000, v126
    v_pk_mul_f32 v[56:57], v[56:57], v[56:57]
    v_cvt_pk_bf16_f32 v126, v56, v57
    buffer_load_dwordx4 a[88:91], v253, s[60:63], s81 offen offset:2048 sc1
    v_cvt_pk_bf16_f32 v127, v58, v59
    v_pk_max_i16 v127, v127, 0
    v_lshlrev_b32_e64 v58, 16, v127
    v_and_b32 v59, 0xffff0000, v127
    v_pk_mul_f32 v[58:59], v[58:59], v[58:59]
    v_cvt_pk_bf16_f32 v127, v58, v59
    v_cvt_pk_bf16_f32 v128, v60, v61
    v_pk_max_i16 v128, v128, 0
    v_lshlrev_b32_e64 v60, 16, v128
    v_and_b32 v61, 0xffff0000, v128
    v_pk_mul_f32 v[60:61], v[60:61], v[60:61]
    v_cvt_pk_bf16_f32 v128, v60, v61
    v_cvt_pk_bf16_f32 v129, v62, v63
    v_pk_max_i16 v129, v129, 0
    buffer_load_dwordx4 a[92:95], v253, s[60:63], s81 offen offset:3072 sc1
    v_lshlrev_b32_e64 v62, 16, v129
    v_and_b32 v63, 0xffff0000, v129
    v_pk_mul_f32 v[62:63], v[62:63], v[62:63]
    v_cvt_pk_bf16_f32 v129, v62, v63
    v_cvt_pk_bf16_f32 v130, v64, v65
    v_pk_max_i16 v130, v130, 0
    v_lshlrev_b32_e64 v64, 16, v130
    v_and_b32 v65, 0xffff0000, v130
    v_pk_mul_f32 v[64:65], v[64:65], v[64:65]
    v_cvt_pk_bf16_f32 v130, v64, v65
    v_cvt_pk_bf16_f32 v131, v66, v67
    v_pk_max_i16 v131, v131, 0
    v_lshlrev_b32_e64 v66, 16, v131
    v_and_b32 v67, 0xffff0000, v131
    v_pk_mul_f32 v[66:67], v[66:67], v[66:67]
    v_cvt_pk_bf16_f32 v131, v66, v67
    buffer_store_dwordx4 v[124:127], v246, s[60:63], s88 offen offset:2048 sc0 sc1
    buffer_store_dwordx4 v[128:131], v246, s[60:63], s88 offen offset:2560 sc0 sc1
    s_mov_b32 exec_lo, 0x77777777
    s_mov_b32 exec_hi, 0x77777777
    ds_write_b128 v106, v[160:163] offset:0
    ds_write_b128 v106, v[164:167] offset:256
    ds_write_b128 v106, v[168:171] offset:512
    ds_write_b128 v106, v[172:175] offset:768
    s_mov_b64 exec, -1
    s_waitcnt lgkmcnt(0)
    s_barrier
    s_nop 0
    ds_read_b128 v[176:179], v92 offset:0
    ds_read2_b32 v[44:45], v93 offset0:0 offset1:1
    ds_read2_b32 v[46:47], v93 offset0:2 offset1:3
    ds_read_b128 v[180:183], v92 offset:64
    ds_read2_b32 v[48:49], v93 offset0:16 offset1:17
    ds_read2_b32 v[50:51], v93 offset0:18 offset1:19
    ds_read_b128 v[184:187], v92 offset:128
    ds_read2_b32 v[52:53], v93 offset0:32 offset1:33
    ds_read2_b32 v[54:55], v93 offset0:34 offset1:35
    v_add_u32 v254, 4096, v253
    v_add_u32 v255, 8192, v253
    s_waitcnt lgkmcnt(6)
    v_mfma_f32_16x16x32_bf16 v[32:35], v[44:47], v[176:179], 0
    ds_read_b128 v[188:191], v92 offset:192
    ds_read2_b32 v[56:57], v93 offset0:48 offset1:49
    ds_read2_b32 v[58:59], v93 offset0:50 offset1:51
    s_waitcnt lgkmcnt(6)
    v_mfma_f32_16x16x32_bf16 v[32:35], v[48:51], v[180:183], v[32:35]
    ds_read_b128 v[192:195], v92 offset:256
    ds_read2_b32 v[44:45], v93 offset0:64 offset1:65
    ds_read2_b32 v[46:47], v93 offset0:66 offset1:67
    s_waitcnt lgkmcnt(6)
    v_mfma_f32_16x16x32_bf16 v[32:35], v[52:55], v[184:187], v[32:35]
    ds_read_b128 v[196:199], v92 offset:320
    ds_read2_b32 v[48:49], v93 offset0:80 offset1:81
    ds_read2_b32 v[50:51], v93 offset0:82 offset1:83
    s_waitcnt lgkmcnt(6)
    v_mfma_f32_16x16x32_bf16 v[32:35], v[56:59], v[188:191], v[32:35]
    ds_read_b128 v[200:203], v92 offset:384
    ds_read2_b32 v[52:53], v93 offset0:96 offset1:97
    ds_read2_b32 v[54:55], v93 offset0:98 offset1:99
    s_waitcnt lgkmcnt(6)
    s_nop 0
    v_mfma_f32_16x16x32_bf16 v[32:35], v[44:47], v[192:195], v[32:35]
    ds_read_b128 v[204:207], v92 offset:448
    v_mfma_f32_16x16x32_bf16 v[28:31], v[44:47], v[176:179], 0
    ds_read2_b32 v[56:57], v93 offset0:112 offset1:113
    ds_read2_b32 v[58:59], v93 offset0:114 offset1:115
    s_waitcnt lgkmcnt(6)
    s_nop 0
    v_mfma_f32_16x16x32_bf16 v[32:35], v[48:51], v[196:199], v[32:35]
    ds_read_b128 v[208:211], v92 offset:512
    v_mfma_f32_16x16x32_bf16 v[28:31], v[48:51], v[180:183], v[28:31]
    ds_read2_b32 v[44:45], v93 offset0:128 offset1:129
    ds_read2_b32 v[46:47], v93 offset0:130 offset1:131
    s_waitcnt lgkmcnt(6)
    s_nop 0
    v_mfma_f32_16x16x32_bf16 v[32:35], v[52:55], v[200:203], v[32:35]
    ds_read_b128 v[212:215], v92 offset:576
    v_mfma_f32_16x16x32_bf16 v[28:31], v[52:55], v[184:187], v[28:31]
    ds_read2_b32 v[48:49], v93 offset0:144 offset1:145
    ds_read2_b32 v[50:51], v93 offset0:146 offset1:147
    s_waitcnt lgkmcnt(6)
    s_nop 0
    v_mfma_f32_16x16x32_bf16 v[32:35], v[56:59], v[204:207], v[32:35]
    ds_read_b128 v[216:219], v92 offset:640
    v_mfma_f32_16x16x32_bf16 v[28:31], v[56:59], v[188:191], v[28:31]
    ds_read2_b32 v[52:53], v93 offset0:160 offset1:161
    ds_read2_b32 v[54:55], v93 offset0:162 offset1:163
    s_waitcnt lgkmcnt(6)
    s_nop 0
    v_mfma_f32_16x16x32_bf16 v[32:35], v[44:47], v[208:211], v[32:35]
    buffer_load_dwordx4 a[96:99], v252, s[60:63], s81 offen offset:3072 sc1
    ds_read_b128 v[220:223], v92 offset:704
    v_mfma_f32_16x16x32_bf16 v[28:31], v[44:47], v[192:195], v[28:31]
    ds_read2_b32 v[56:57], v93 offset0:176 offset1:177
    v_mfma_f32_16x16x32_bf16 v[24:27], v[44:47], v[176:179], 0
    s_add_u32 s81, s81, 40960
    ds_read2_b32 v[58:59], v93 offset0:178 offset1:179
    s_waitcnt lgkmcnt(6)
    s_nop 0
    v_mfma_f32_16x16x32_bf16 v[32:35], v[48:51], v[212:215], v[32:35]
    ds_read_b128 v[224:227], v92 offset:768
    v_mfma_f32_16x16x32_bf16 v[28:31], v[48:51], v[196:199], v[28:31]
    buffer_load_dwordx4 a[100:103], v253, s[60:63], s81 offen offset:0 sc1
    ds_read2_b32 v[44:45], v93 offset0:192 offset1:193
    v_mfma_f32_16x16x32_bf16 v[24:27], v[48:51], v[180:183], v[24:27]
    ds_read2_b32 v[46:47], v93 offset0:194 offset1:195
    s_waitcnt lgkmcnt(6)
    s_nop 0
    v_mfma_f32_16x16x32_bf16 v[32:35], v[52:55], v[216:219], v[32:35]
    buffer_load_dwordx4 a[104:107], v253, s[60:63], s81 offen offset:1024 sc1
    ds_read_b128 v[228:231], v92 offset:832
    v_mfma_f32_16x16x32_bf16 v[28:31], v[52:55], v[200:203], v[28:31]
    ds_read2_b32 v[48:49], v93 offset0:208 offset1:209
    v_mfma_f32_16x16x32_bf16 v[24:27], v[52:55], v[184:187], v[24:27]
    buffer_load_dwordx4 a[108:111], v253, s[60:63], s81 offen offset:2048 sc1
    ds_read2_b32 v[50:51], v93 offset0:210 offset1:211
    s_waitcnt lgkmcnt(6)
    s_nop 0
    v_mfma_f32_16x16x32_bf16 v[32:35], v[56:59], v[220:223], v[32:35]
    ds_read_b128 v[232:235], v92 offset:896
    v_mfma_f32_16x16x32_bf16 v[28:31], v[56:59], v[204:207], v[28:31]
    buffer_load_dwordx4 a[112:115], v253, s[60:63], s81 offen offset:3072 sc1
    ds_read2_b32 v[52:53], v93 offset0:224 offset1:225
    v_mfma_f32_16x16x32_bf16 v[24:27], v[56:59], v[188:191], v[24:27]
    ds_read2_b32 v[54:55], v93 offset0:226 offset1:227
    s_waitcnt lgkmcnt(6)
    s_nop 0
    v_mfma_f32_16x16x32_bf16 v[32:35], v[44:47], v[224:227], v[32:35]
    ds_read_b128 v[236:239], v92 offset:960
    v_mfma_f32_16x16x32_bf16 v[28:31], v[44:47], v[208:211], v[28:31]
    buffer_load_dwordx4 a[116:119], v252, s[60:63], s81 offen offset:3072 sc1
    ds_read2_b32 v[56:57], v93 offset0:240 offset1:241
    v_mfma_f32_16x16x32_bf16 v[24:27], v[44:47], v[192:195], v[24:27]
    ds_read2_b32 v[58:59], v93 offset0:242 offset1:243
    v_mfma_f32_16x16x32_bf16 v[20:23], v[44:47], v[176:179], 0
    s_add_u32 s81, s81, 40960
    s_waitcnt lgkmcnt(6)
    v_mfma_f32_16x16x32_bf16 v[32:35], v[48:51], v[228:231], v[32:35]
    ds_read_b128 v[176:179], v92 offset:1024
    v_mfma_f32_16x16x32_bf16 v[28:31], v[48:51], v[212:215], v[28:31]
    s_sub_u32 s81, s81, s22
    ds_read2_b32 v[44:45], v94 offset0:0 offset1:1
    v_mfma_f32_16x16x32_bf16 v[24:27], v[48:51], v[196:199], v[24:27]
    ds_read2_b32 v[46:47], v94 offset0:2 offset1:3
    v_mfma_f32_16x16x32_bf16 v[20:23], v[48:51], v[180:183], v[20:23]
    buffer_load_dwordx4 a[120:123], v253, s[60:63], s81 offen offset:0 sc1
    s_waitcnt lgkmcnt(6)
    s_nop 0
    v_mfma_f32_16x16x32_bf16 v[32:35], v[52:55], v[232:235], v[32:35]
    buffer_load_dwordx4 a[124:127], v253, s[60:63], s81 offen offset:1024 sc1
    ds_read_b128 v[180:183], v92 offset:1088
    v_mfma_f32_16x16x32_bf16 v[28:31], v[52:55], v[216:219], v[28:31]
    ds_read2_b32 v[48:49], v94 offset0:16 offset1:17
    v_mfma_f32_16x16x32_bf16 v[24:27], v[52:55], v[200:203], v[24:27]
    ds_read2_b32 v[50:51], v94 offset0:18 offset1:19
    v_mfma_f32_16x16x32_bf16 v[20:23], v[52:55], v[184:187], v[20:23]
    buffer_load_dwordx4 a[128:131], v253, s[60:63], s81 offen offset:2048 sc1
    s_waitcnt lgkmcnt(6)
    s_nop 0
    v_mfma_f32_16x16x32_bf16 v[32:35], v[56:59], v[236:239], v[32:35]
    buffer_load_dwordx4 a[132:135], v253, s[60:63], s81 offen offset:3072 sc1
    ds_read_b128 v[184:187], v92 offset:1152
    v_mfma_f32_16x16x32_bf16 v[28:31], v[56:59], v[220:223], v[28:31]
    ds_read2_b32 v[52:53], v94 offset0:32 offset1:33
    v_mfma_f32_16x16x32_bf16 v[24:27], v[56:59], v[204:207], v[24:27]
    ds_read2_b32 v[54:55], v94 offset0:34 offset1:35
    v_mfma_f32_16x16x32_bf16 v[20:23], v[56:59], v[188:191], v[20:23]
    v_add_u32 v92, 1024, v92
    v_add_u32 v93, 1056, v93
    v_add_u32 v94, 1056, v94
    v_cvt_pk_bf16_f32 v42, v32, v33
    v_cvt_pk_bf16_f32 v43, v34, v35
    v_cvt_pk_bf16_f32 v40, v28, v29
    v_cvt_pk_bf16_f32 v41, v30, v31
    v_cvt_pk_bf16_f32 v38, v24, v25
    v_cvt_pk_bf16_f32 v39, v26, v27
    v_cvt_pk_bf16_f32 v36, v20, v21
    v_cvt_pk_bf16_f32 v37, v22, v23
    s_waitcnt lgkmcnt(6)
    s_nop 0
    v_mfma_f32_16x16x32_bf16 v[32:35], v[44:47], v[176:179], v[32:35]
    buffer_load_dwordx4 a[136:139], v252, s[60:63], s81 offen offset:3072 sc1
    ds_read_b128 v[188:191], v92 offset:192
    v_mfma_f32_16x16x32_bf16 v[28:31], v[44:47], v[224:227], v[28:31]
    ds_read2_b32 v[56:57], v93 offset0:48 offset1:49
    v_mfma_f32_16x16x32_bf16 v[24:27], v[44:47], v[208:211], v[24:27]
    s_add_u32 s81, s81, 40960
    ds_read2_b32 v[58:59], v93 offset0:50 offset1:51
    v_mfma_f32_16x16x32_bf16 v[20:23], v[44:47], v[192:195], v[20:23]
    s_waitcnt lgkmcnt(6)
    s_nop 0
    v_mfma_f32_16x16x32_bf16 v[32:35], v[48:51], v[180:183], v[32:35]
    buffer_load_dwordx4 a[140:143], v253, s[60:63], s81 offen offset:0 sc1
    ds_read_b128 v[192:195], v92 offset:256
    v_mfma_f32_16x16x32_bf16 v[28:31], v[48:51], v[228:231], v[28:31]
    ds_read2_b32 v[44:45], v93 offset0:64 offset1:65
    v_mfma_f32_16x16x32_bf16 v[24:27], v[48:51], v[212:215], v[24:27]
    buffer_load_dwordx4 a[144:147], v253, s[60:63], s81 offen offset:1024 sc1
    ds_read2_b32 v[46:47], v93 offset0:66 offset1:67
    v_mfma_f32_16x16x32_bf16 v[20:23], v[48:51], v[196:199], v[20:23]
    s_waitcnt lgkmcnt(6)
    v_mfma_f32_16x16x32_bf16 v[32:35], v[52:55], v[184:187], v[32:35]
    s_waitcnt vmcnt(13)
    buffer_store_dword v241, v242, s[60:63], s89 offen sc0 sc1
    ds_read_b128 v[196:199], v92 offset:320
    v_mfma_f32_16x16x32_bf16 v[28:31], v[52:55], v[232:235], v[28:31]
    ds_read2_b32 v[48:49], v93 offset0:80 offset1:81
    v_mfma_f32_16x16x32_bf16 v[24:27], v[52:55], v[216:219], v[24:27]
    buffer_load_dwordx4 a[148:151], v253, s[60:63], s81 offen offset:2048 sc1
    ds_read2_b32 v[50:51], v93 offset0:82 offset1:83
    v_mfma_f32_16x16x32_bf16 v[20:23], v[52:55], v[200:203], v[20:23]
    s_waitcnt lgkmcnt(6)
    s_nop 0
    v_mfma_f32_16x16x32_bf16 v[32:35], v[56:59], v[188:191], v[32:35]
    buffer_load_dwordx4 a[152:155], v253, s[60:63], s81 offen offset:3072 sc1
    ds_read_b128 v[200:203], v92 offset:384
    v_mfma_f32_16x16x32_bf16 v[28:31], v[56:59], v[236:239], v[28:31]
    ds_read2_b32 v[52:53], v93 offset0:96 offset1:97
    v_mfma_f32_16x16x32_bf16 v[24:27], v[56:59], v[220:223], v[24:27]
    buffer_load_dwordx4 a[156:159], v252, s[60:63], s81 offen offset:3072 sc1
    ds_read2_b32 v[54:55], v93 offset0:98 offset1:99
    v_mfma_f32_16x16x32_bf16 v[20:23], v[56:59], v[204:207], v[20:23]
    s_waitcnt lgkmcnt(6)
    s_nop 0
    v_mfma_f32_16x16x32_bf16 v[32:35], v[44:47], v[192:195], v[32:35]
    ds_read_b128 v[204:207], v92 offset:448
    v_mfma_f32_16x16x32_bf16 v[28:31], v[44:47], v[176:179], v[28:31]
    s_add_u32 s81, s81, 40960
    ds_read2_b32 v[56:57], v93 offset0:112 offset1:113
    v_mfma_f32_16x16x32_bf16 v[24:27], v[44:47], v[224:227], v[24:27]
    ds_read2_b32 v[58:59], v93 offset0:114 offset1:115
    v_mfma_f32_16x16x32_bf16 v[20:23], v[44:47], v[208:211], v[20:23]
    buffer_load_dwordx4 a[160:163], v253, s[60:63], s81 offen offset:0 sc1
    s_waitcnt lgkmcnt(6)
    s_nop 0
    v_mfma_f32_16x16x32_bf16 v[32:35], v[48:51], v[196:199], v[32:35]
    ds_read_b128 v[208:211], v92 offset:512
    v_mfma_f32_16x16x32_bf16 v[28:31], v[48:51], v[180:183], v[28:31]
    buffer_load_dwordx4 a[164:167], v253, s[60:63], s81 offen offset:1024 sc1
    ds_read2_b32 v[44:45], v93 offset0:128 offset1:129
    v_mfma_f32_16x16x32_bf16 v[24:27], v[48:51], v[228:231], v[24:27]
    ds_read2_b32 v[46:47], v93 offset0:130 offset1:131
    v_mfma_f32_16x16x32_bf16 v[20:23], v[48:51], v[212:215], v[20:23]
    buffer_load_dwordx4 a[168:171], v253, s[60:63], s81 offen offset:2048 sc1
    s_waitcnt lgkmcnt(6)
    s_nop 0
    v_mfma_f32_16x16x32_bf16 v[32:35], v[52:55], v[200:203], v[32:35]
    ds_read_b128 v[212:215], v92 offset:576
    v_mfma_f32_16x16x32_bf16 v[28:31], v[52:55], v[184:187], v[28:31]
    ds_read2_b32 v[48:49], v93 offset0:144 offset1:145
    v_mfma_f32_16x16x32_bf16 v[24:27], v[52:55], v[232:235], v[24:27]
    buffer_load_dwordx4 a[172:175], v253, s[60:63], s81 offen offset:3072 sc1
    ds_read2_b32 v[50:51], v93 offset0:146 offset1:147
    v_mfma_f32_16x16x32_bf16 v[20:23], v[52:55], v[216:219], v[20:23]
    s_waitcnt lgkmcnt(6)
    s_nop 0
    v_mfma_f32_16x16x32_bf16 v[32:35], v[56:59], v[204:207], v[32:35]
    s_mul_i32 s11, s3, 6144
    ds_read_b128 v[216:219], v92 offset:640
    v_mfma_f32_16x16x32_bf16 v[28:31], v[56:59], v[188:191], v[28:31]
    ds_read2_b32 v[52:53], v93 offset0:160 offset1:161
    v_mfma_f32_16x16x32_bf16 v[24:27], v[56:59], v[236:239], v[24:27]
    s_add_u32 s11, s11, 102400
    ds_read2_b32 v[54:55], v93 offset0:162 offset1:163
    v_mfma_f32_16x16x32_bf16 v[20:23], v[56:59], v[220:223], v[20:23]
    s_waitcnt lgkmcnt(6)
    v_mfma_f32_16x16x32_bf16 v[32:35], v[44:47], v[208:211], v[32:35]
    ds_read_b128 v[220:223], v92 offset:704
    v_mfma_f32_16x16x32_bf16 v[28:31], v[44:47], v[192:195], v[28:31]
    s_add_u32 m0, s11, 0
    ds_read2_b32 v[56:57], v93 offset0:176 offset1:177
    v_mfma_f32_16x16x32_bf16 v[24:27], v[44:47], v[176:179], v[24:27]
    ds_read2_b32 v[58:59], v93 offset0:178 offset1:179
    v_mfma_f32_16x16x32_bf16 v[20:23], v[44:47], v[224:227], v[20:23]
    buffer_load_dwordx4 v95, s[48:51], s87 offen lds
    s_waitcnt lgkmcnt(6)
    s_nop 0
    v_mfma_f32_16x16x32_bf16 v[32:35], v[48:51], v[212:215], v[32:35]
    ds_read_b128 v[224:227], v92 offset:768
    v_mfma_f32_16x16x32_bf16 v[28:31], v[48:51], v[196:199], v[28:31]
    s_add_u32 m0, s11, 1024
    ds_read2_b32 v[44:45], v93 offset0:192 offset1:193
    v_mfma_f32_16x16x32_bf16 v[24:27], v[48:51], v[180:183], v[24:27]
    ds_read2_b32 v[46:47], v93 offset0:194 offset1:195
    v_mfma_f32_16x16x32_bf16 v[20:23], v[48:51], v[228:231], v[20:23]
    s_waitcnt lgkmcnt(6)
    s_nop 0
    v_mfma_f32_16x16x32_bf16 v[32:35], v[52:55], v[216:219], v[32:35]
    buffer_load_dwordx4 v96, s[48:51], s87 offen lds
    ds_read_b128 v[228:231], v92 offset:832
    v_mfma_f32_16x16x32_bf16 v[28:31], v[52:55], v[200:203], v[28:31]
    ds_read2_b32 v[48:49], v93 offset0:208 offset1:209
    v_mfma_f32_16x16x32_bf16 v[24:27], v[52:55], v[184:187], v[24:27]
    s_add_u32 m0, s11, 2048
    ds_read2_b32 v[50:51], v93 offset0:210 offset1:211
    v_mfma_f32_16x16x32_bf16 v[20:23], v[52:55], v[232:235], v[20:23]
    s_waitcnt lgkmcnt(6)
    s_nop 0
    v_mfma_f32_16x16x32_bf16 v[32:35], v[56:59], v[220:223], v[32:35]
    buffer_load_dwordx4 v97, s[48:51], s87 offen lds
    ds_read_b128 v[232:235], v92 offset:896
    v_mfma_f32_16x16x32_bf16 v[28:31], v[56:59], v[204:207], v[28:31]
    ds_read2_b32 v[52:53], v93 offset0:224 offset1:225
    v_mfma_f32_16x16x32_bf16 v[24:27], v[56:59], v[188:191], v[24:27]
    s_add_u32 m0, s11, 3072
    ds_read2_b32 v[54:55], v93 offset0:226 offset1:227
    v_mfma_f32_16x16x32_bf16 v[20:23], v[56:59], v[236:239], v[20:23]
    s_waitcnt lgkmcnt(6)
    s_nop 0
    v_mfma_f32_16x16x32_bf16 v[32:35], v[44:47], v[224:227], v[32:35]
    ds_read_b128 v[236:239], v92 offset:960
    v_mfma_f32_16x16x32_bf16 v[28:31], v[44:47], v[208:211], v[28:31]
    buffer_load_dwordx4 v247, s[60:63], s86 offen offset:0 sc1 lds
    ds_read2_b32 v[56:57], v93 offset0:240 offset1:241
    v_mfma_f32_16x16x32_bf16 v[24:27], v[44:47], v[192:195], v[24:27]
    ds_read2_b32 v[58:59], v93 offset0:242 offset1:243
    v_mfma_f32_16x16x32_bf16 v[20:23], v[44:47], v[176:179], v[20:23]
    s_add_u32 m0, s11, 2048
    s_waitcnt lgkmcnt(6)
    s_nop 0
    v_mfma_f32_16x16x32_bf16 v[32:35], v[48:51], v[228:231], v[32:35]
    ds_read_b128 v[176:179], v92 offset:1024
    v_mfma_f32_16x16x32_bf16 v[28:31], v[48:51], v[212:215], v[28:31]
    buffer_load_dwordx4 v247, s[60:63], s86 offen offset:2048 sc1 lds
    ds_read2_b32 v[44:45], v94 offset0:0 offset1:1
    v_mfma_f32_16x16x32_bf16 v[24:27], v[48:51], v[196:199], v[24:27]
    ds_read2_b32 v[46:47], v94 offset0:2 offset1:3
    v_mfma_f32_16x16x32_bf16 v[20:23], v[48:51], v[180:183], v[20:23]
    s_waitcnt lgkmcnt(6)
    s_nop 0
    v_mfma_f32_16x16x32_bf16 v[32:35], v[52:55], v[232:235], v[32:35]
    s_add_u32 m0, s11, 5120
    ds_read_b128 v[180:183], v92 offset:1088
    v_mfma_f32_16x16x32_bf16 v[28:31], v[52:55], v[216:219], v[28:31]
    ds_read2_b32 v[48:49], v94 offset0:16 offset1:17
    v_mfma_f32_16x16x32_bf16 v[24:27], v[52:55], v[200:203], v[24:27]
    s_add_u32 s86, s86, 4096
    ds_read2_b32 v[50:51], v94 offset0:18 offset1:19
    v_mfma_f32_16x16x32_bf16 v[20:23], v[52:55], v[184:187], v[20:23]
    s_waitcnt lgkmcnt(6)
    s_nop 0
    v_mfma_f32_16x16x32_bf16 v[32:35], v[56:59], v[236:239], v[32:35]
    buffer_load_dwordx4 v247, s[60:63], s86 offen sc1 lds
    ds_read_b128 v[184:187], v92 offset:1152
    v_mfma_f32_16x16x32_bf16 v[28:31], v[56:59], v[220:223], v[28:31]
    ds_read2_b32 v[52:53], v94 offset0:32 offset1:33
    v_mfma_f32_16x16x32_bf16 v[24:27], v[56:59], v[204:207], v[24:27]
    ds_read2_b32 v[54:55], v94 offset0:34 offset1:35
    v_mfma_f32_16x16x32_bf16 v[20:23], v[56:59], v[188:191], v[20:23]
    v_add_u32 v92, 1024, v92
    v_add_u32 v93, 1056, v93
    v_add_u32 v94, 1056, v94
    s_lshl_b32 s75, s82, 7
    s_lshl_b32 s12, s3, 2
    s_add_u32 s75, s75, s12
    s_add_u32 s75, s75, 22282240
    s_cmp_eq_u32 s99, 1
    s_cbranch_scc1 .Lb2x
    s_waitcnt lgkmcnt(6)
    v_mfma_f32_16x16x32_bf16 v[32:35], v[44:47], v[176:179], v[32:35]
    buffer_load_dwordx4 a[176:179], v252, s[60:63], s81 offen offset:3072 sc1
    ds_read_b128 v[188:191], v92 offset:192
    v_mfma_f32_16x16x32_bf16 v[28:31], v[44:47], v[224:227], v[28:31]
    ds_read2_b32 v[56:57], v93 offset0:48 offset1:49
    v_mfma_f32_16x16x32_bf16 v[24:27], v[44:47], v[208:211], v[24:27]
    ds_read2_b32 v[58:59], v93 offset0:50 offset1:51
    v_mfma_f32_16x16x32_bf16 v[20:23], v[44:47], v[192:195], v[20:23]
    s_add_u32 s81, s81, 40960
    s_waitcnt lgkmcnt(6)
    s_nop 0
    v_mfma_f32_16x16x32_bf16 v[32:35], v[48:51], v[180:183], v[32:35]
    ds_read_b128 v[192:195], v92 offset:256
    v_mfma_f32_16x16x32_bf16 v[28:31], v[48:51], v[228:231], v[28:31]
    ds_read2_b32 v[44:45], v93 offset0:64 offset1:65
    v_mfma_f32_16x16x32_bf16 v[24:27], v[48:51], v[212:215], v[24:27]
    buffer_load_dwordx4 a[180:183], v253, s[60:63], s81 offen offset:0 sc1
    ds_read2_b32 v[46:47], v93 offset0:66 offset1:67
    v_mfma_f32_16x16x32_bf16 v[20:23], v[48:51], v[196:199], v[20:23]
    s_waitcnt lgkmcnt(6)
    s_nop 0
    v_mfma_f32_16x16x32_bf16 v[32:35], v[52:55], v[184:187], v[32:35]
    ds_read_b128 v[196:199], v92 offset:320
    v_mfma_f32_16x16x32_bf16 v[28:31], v[52:55], v[232:235], v[28:31]
    buffer_load_dwordx4 a[184:187], v253, s[60:63], s81 offen offset:1024 sc1
    ds_read2_b32 v[48:49], v93 offset0:80 offset1:81
    v_mfma_f32_16x16x32_bf16 v[24:27], v[52:55], v[216:219], v[24:27]
    ds_read2_b32 v[50:51], v93 offset0:82 offset1:83
    v_mfma_f32_16x16x32_bf16 v[20:23], v[52:55], v[200:203], v[20:23]
    s_waitcnt lgkmcnt(6)
    s_nop 0
    v_mfma_f32_16x16x32_bf16 v[32:35], v[56:59], v[188:191], v[32:35]
    buffer_load_dwordx4 a[188:191], v253, s[60:63], s81 offen offset:2048 sc1
    ds_read_b128 v[200:203], v92 offset:384
    v_mfma_f32_16x16x32_bf16 v[28:31], v[56:59], v[236:239], v[28:31]
    ds_read2_b32 v[52:53], v93 offset0:96 offset1:97
    v_mfma_f32_16x16x32_bf16 v[24:27], v[56:59], v[220:223], v[24:27]
    ds_read2_b32 v[54:55], v93 offset0:98 offset1:99
    v_mfma_f32_16x16x32_bf16 v[20:23], v[56:59], v[204:207], v[20:23]
    buffer_load_dwordx4 a[192:195], v253, s[60:63], s81 offen offset:3072 sc1
    s_waitcnt lgkmcnt(6)
    s_nop 0
    v_mfma_f32_16x16x32_bf16 v[32:35], v[44:47], v[192:195], v[32:35]
    ds_read_b128 v[204:207], v92 offset:448
    v_mfma_f32_16x16x32_bf16 v[28:31], v[44:47], v[176:179], v[28:31]
    ds_read2_b32 v[56:57], v93 offset0:112 offset1:113
    v_mfma_f32_16x16x32_bf16 v[24:27], v[44:47], v[224:227], v[24:27]
    buffer_load_dwordx4 a[196:199], v252, s[60:63], s81 offen offset:3072 sc1
    ds_read2_b32 v[58:59], v93 offset0:114 offset1:115
    v_mfma_f32_16x16x32_bf16 v[20:23], v[44:47], v[208:211], v[20:23]
    s_waitcnt lgkmcnt(6)
    s_nop 0
    v_mfma_f32_16x16x32_bf16 v[32:35], v[48:51], v[196:199], v[32:35]
    buffer_load_dword v62, v250, s[60:63], 0 offen sc0 sc1
    ds_read_b128 v[208:211], v92 offset:512
    v_mfma_f32_16x16x32_bf16 v[28:31], v[48:51], v[180:183], v[28:31]
    s_add_u32 s81, s81, 40960
    ds_read2_b32 v[44:45], v93 offset0:128 offset1:129
    v_mfma_f32_16x16x32_bf16 v[24:27], v[48:51], v[228:231], v[24:27]
    ds_read2_b32 v[46:47], v93 offset0:130 offset1:131
    v_mfma_f32_16x16x32_bf16 v[20:23], v[48:51], v[212:215], v[20:23]
    s_waitcnt lgkmcnt(6)
    s_nop 0
    v_mfma_f32_16x16x32_bf16 v[32:35], v[52:55], v[200:203], v[32:35]
    buffer_load_dwordx4 a[200:203], v253, s[60:63], s81 offen offset:0 sc1
    ds_read_b128 v[212:215], v92 offset:576
    v_mfma_f32_16x16x32_bf16 v[28:31], v[52:55], v[184:187], v[28:31]
    ds_read2_b32 v[48:49], v93 offset0:144 offset1:145
    v_mfma_f32_16x16x32_bf16 v[24:27], v[52:55], v[232:235], v[24:27]
    ds_read2_b32 v[50:51], v93 offset0:146 offset1:147
    v_mfma_f32_16x16x32_bf16 v[20:23], v[52:55], v[216:219], v[20:23]
    buffer_load_dwordx4 a[204:207], v253, s[60:63], s81 offen offset:1024 sc1
    s_waitcnt lgkmcnt(6)
    s_nop 0
    v_mfma_f32_16x16x32_bf16 v[32:35], v[56:59], v[204:207], v[32:35]
    ds_read_b128 v[216:219], v92 offset:640
    v_mfma_f32_16x16x32_bf16 v[28:31], v[56:59], v[188:191], v[28:31]
    ds_read2_b32 v[52:53], v93 offset0:160 offset1:161
    v_mfma_f32_16x16x32_bf16 v[24:27], v[56:59], v[236:239], v[24:27]
    buffer_load_dwordx4 a[208:211], v253, s[60:63], s81 offen offset:2048 sc1
    ds_read2_b32 v[54:55], v93 offset0:162 offset1:163
    v_mfma_f32_16x16x32_bf16 v[20:23], v[56:59], v[220:223], v[20:23]
    s_waitcnt lgkmcnt(6)
    s_nop 0
    v_mfma_f32_16x16x32_bf16 v[32:35], v[44:47], v[208:211], v[32:35]
    ds_read_b128 v[220:223], v92 offset:704
    v_mfma_f32_16x16x32_bf16 v[28:31], v[44:47], v[192:195], v[28:31]
    buffer_load_dwordx4 a[212:215], v253, s[60:63], s81 offen offset:3072 sc1
    ds_read2_b32 v[56:57], v93 offset0:176 offset1:177
    v_mfma_f32_16x16x32_bf16 v[24:27], v[44:47], v[176:179], v[24:27]
    ds_read2_b32 v[58:59], v93 offset0:178 offset1:179
    v_mfma_f32_16x16x32_bf16 v[20:23], v[44:47], v[224:227], v[20:23]
    s_waitcnt lgkmcnt(6)
    s_nop 0
    v_mfma_f32_16x16x32_bf16 v[32:35], v[48:51], v[212:215], v[32:35]
    buffer_load_dwordx4 a[216:219], v252, s[60:63], s81 offen offset:3072 sc1
    ds_read_b128 v[224:227], v92 offset:768
    v_mfma_f32_16x16x32_bf16 v[28:31], v[48:51], v[196:199], v[28:31]
    ds_read2_b32 v[44:45], v93 offset0:192 offset1:193
    v_mfma_f32_16x16x32_bf16 v[24:27], v[48:51], v[180:183], v[24:27]
    ds_read2_b32 v[46:47], v93 offset0:194 offset1:195
    v_mfma_f32_16x16x32_bf16 v[20:23], v[48:51], v[228:231], v[20:23]
    s_add_u32 s81, s81, 40960
    s_waitcnt lgkmcnt(6)
    s_nop 0
    v_mfma_f32_16x16x32_bf16 v[32:35], v[52:55], v[216:219], v[32:35]
    ds_read_b128 v[228:231], v92 offset:832
    v_mfma_f32_16x16x32_bf16 v[28:31], v[52:55], v[200:203], v[28:31]
    ds_read2_b32 v[48:49], v93 offset0:208 offset1:209
    v_mfma_f32_16x16x32_bf16 v[24:27], v[52:55], v[184:187], v[24:27]
    buffer_load_dwordx4 a[220:223], v253, s[60:63], s81 offen offset:0 sc1
    ds_read2_b32 v[50:51], v93 offset0:210 offset1:211
    v_mfma_f32_16x16x32_bf16 v[20:23], v[52:55], v[232:235], v[20:23]
    s_waitcnt lgkmcnt(6)
    s_nop 0
    v_mfma_f32_16x16x32_bf16 v[32:35], v[56:59], v[220:223], v[32:35]
    ds_read_b128 v[232:235], v92 offset:896
    v_mfma_f32_16x16x32_bf16 v[28:31], v[56:59], v[204:207], v[28:31]
    buffer_load_dwordx4 a[224:227], v253, s[60:63], s81 offen offset:1024 sc1
    ds_read2_b32 v[52:53], v93 offset0:224 offset1:225
    v_mfma_f32_16x16x32_bf16 v[24:27], v[56:59], v[188:191], v[24:27]
    ds_read2_b32 v[54:55], v93 offset0:226 offset1:227
    v_mfma_f32_16x16x32_bf16 v[20:23], v[56:59], v[236:239], v[20:23]
    s_waitcnt lgkmcnt(6)
    s_nop 0
    v_mfma_f32_16x16x32_bf16 v[32:35], v[44:47], v[224:227], v[32:35]
    buffer_load_dwordx4 a[228:231], v253, s[60:63], s81 offen offset:2048 sc1
    ds_read_b128 v[236:239], v92 offset:960
    v_mfma_f32_16x16x32_bf16 v[28:31], v[44:47], v[208:211], v[28:31]
    ds_read2_b32 v[56:57], v93 offset0:240 offset1:241
    v_mfma_f32_16x16x32_bf16 v[24:27], v[44:47], v[192:195], v[24:27]
    ds_read2_b32 v[58:59], v93 offset0:242 offset1:243
    v_mfma_f32_16x16x32_bf16 v[20:23], v[44:47], v[176:179], v[20:23]
    buffer_load_dwordx4 a[232:235], v253, s[60:63], s81 offen offset:3072 sc1
    s_waitcnt lgkmcnt(6)
    s_nop 0
    v_mfma_f32_16x16x32_bf16 v[32:35], v[48:51], v[228:231], v[32:35]
    ds_read_b128 v[176:179], v92 offset:1024
    v_mfma_f32_16x16x32_bf16 v[28:31], v[48:51], v[212:215], v[28:31]
    ds_read2_b32 v[44:45], v94 offset0:0 offset1:1
    v_mfma_f32_16x16x32_bf16 v[24:27], v[48:51], v[196:199], v[24:27]
    buffer_load_dwordx4 a[236:239], v252, s[60:63], s81 offen offset:3072 sc1
    ds_read2_b32 v[46:47], v94 offset0:2 offset1:3
    v_mfma_f32_16x16x32_bf16 v[20:23], v[48:51], v[180:183], v[20:23]
    s_waitcnt lgkmcnt(6)
    s_nop 0
    v_mfma_f32_16x16x32_bf16 v[32:35], v[52:55], v[232:235], v[32:35]
    ds_read_b128 v[180:183], v92 offset:1088
    v_mfma_f32_16x16x32_bf16 v[28:31], v[52:55], v[216:219], v[28:31]
    ds_read2_b32 v[48:49], v94 offset0:16 offset1:17
    v_mfma_f32_16x16x32_bf16 v[24:27], v[52:55], v[200:203], v[24:27]
    s_waitcnt vmcnt(10)
    v_xor_b32 v62, s10, v62
    v_cmp_ne_u32 vcc, 0, v62
    ds_read2_b32 v[50:51], v94 offset0:18 offset1:19
    v_mfma_f32_16x16x32_bf16 v[20:23], v[52:55], v[184:187], v[20:23]
    s_cbranch_vccnz .Lhskipa0
    buffer_load_dwordx4 v[108:111], v253, s[60:63], s90 offen offset:0 sc1
.Lhskipa0:
    s_waitcnt lgkmcnt(6)
    s_nop 0
    v_mfma_f32_16x16x32_bf16 v[32:35], v[56:59], v[236:239], v[32:35]
    ds_read_b128 v[184:187], v92 offset:1152
    v_mfma_f32_16x16x32_bf16 v[28:31], v[56:59], v[220:223], v[28:31]
    ds_read2_b32 v[52:53], v94 offset0:32 offset1:33
    v_mfma_f32_16x16x32_bf16 v[24:27], v[56:59], v[204:207], v[24:27]
    ds_read2_b32 v[54:55], v94 offset0:34 offset1:35
    v_mfma_f32_16x16x32_bf16 v[20:23], v[56:59], v[188:191], v[20:23]
    v_add_u32 v92, 1024, v92
    v_add_u32 v93, 1056, v93
    v_add_u32 v94, 1056, v94
    s_waitcnt lgkmcnt(0)
    s_branch .Lb3
.Lb2x:
    s_mov_b32 exec_lo, 0
    s_nop 0
    v_cvt_pk_bf16_f32 v42, v32, v33
    v_cvt_pk_bf16_f32 v43, v34, v35
    v_cvt_pk_bf16_f32 v40, v28, v29
    v_cvt_pk_bf16_f32 v41, v30, v31
    v_cvt_pk_bf16_f32 v38, v24, v25
    v_cvt_pk_bf16_f32 v39, v26, v27
    v_cvt_pk_bf16_f32 v36, v20, v21
    v_cvt_pk_bf16_f32 v37, v22, v23
    s_mov_b32 exec_lo, -1
    v_permlane16_swap_b32 v36, v38
    v_permlane16_swap_b32 v37, v39
    buffer_store_dwordx4 v[36:39], v103, s[60:63], s74 offen offset:0 sc0 sc1
    v_permlane16_swap_b32 v40, v42
    v_permlane16_swap_b32 v41, v43
    buffer_store_dwordx4 v[40:43], v103, s[60:63], s74 offen offset:512 sc0 sc1
    s_mul_i32 s12, s98, 4352
    v_add_u32 v92, s12, v101
    s_mul_i32 s12, s98, 8704
    s_mul_i32 s13, s99, 2112
    s_add_u32 s12, s12, s13
    v_add_u32 v93, s12, v102
    v_add_u32 v94, 1056, v93
    s_add_u32 s12, s8, s98
    s_mul_i32 s12, s12, 8192
    s_lshl_b32 s13, s99, 11
    s_sub_u32 s12, s12, s13
    s_add_u32 s74, s12, 16779264
    s_nop 0
    s_waitcnt lgkmcnt(8)
    ds_read_b128 v[176:179], v92 offset:0
    s_waitcnt lgkmcnt(8)
    ds_read2_b32 v[44:45], v93 offset0:0 offset1:1
    s_waitcnt lgkmcnt(8)
    ds_read2_b32 v[46:47], v93 offset0:2 offset1:3
    s_waitcnt lgkmcnt(8)
    ds_read_b128 v[180:183], v92 offset:64
    s_waitcnt lgkmcnt(8)
    ds_read2_b32 v[48:49], v93 offset0:16 offset1:17
    s_waitcnt lgkmcnt(8)
    ds_read2_b32 v[50:51], v93 offset0:18 offset1:19
    s_waitcnt lgkmcnt(8)
    ds_read_b128 v[184:187], v92 offset:128
    s_waitcnt lgkmcnt(8)
    ds_read2_b32 v[52:53], v93 offset0:32 offset1:33
    s_waitcnt lgkmcnt(8)
    ds_read2_b32 v[54:55], v93 offset0:34 offset1:35
    s_waitcnt lgkmcnt(6)
    v_mfma_f32_16x16x32_bf16 v[32:35], v[44:47], v[176:179], 0
    buffer_load_dword v62, v250, s[60:63], 0 offen sc0 sc1
    buffer_load_dwordx4 a[176:179], v252, s[60:63], s81 offen offset:3072 sc1
    ds_read_b128 v[188:191], v92 offset:192
    ds_read2_b32 v[56:57], v93 offset0:48 offset1:49
    ds_read2_b32 v[58:59], v93 offset0:50 offset1:51
    s_waitcnt lgkmcnt(6)
    s_nop 0
    v_mfma_f32_16x16x32_bf16 v[32:35], v[48:51], v[180:183], v[32:35]
    s_add_u32 s81, s81, 40960
    ds_read_b128 v[192:195], v92 offset:256
    ds_read2_b32 v[44:45], v93 offset0:64 offset1:65
    ds_read2_b32 v[46:47], v93 offset0:66 offset1:67
    s_waitcnt lgkmcnt(6)
    v_mfma_f32_16x16x32_bf16 v[32:35], v[52:55], v[184:187], v[32:35]
    ds_read_b128 v[196:199], v92 offset:320
    ds_read2_b32 v[48:49], v93 offset0:80 offset1:81
    ds_read2_b32 v[50:51], v93 offset0:82 offset1:83
    s_waitcnt lgkmcnt(6)
    v_mfma_f32_16x16x32_bf16 v[32:35], v[56:59], v[188:191], v[32:35]
    buffer_load_dwordx4 a[180:183], v253, s[60:63], s81 offen offset:0 sc1
    ds_read_b128 v[200:203], v92 offset:384
    ds_read2_b32 v[52:53], v93 offset0:96 offset1:97
    ds_read2_b32 v[54:55], v93 offset0:98 offset1:99
    s_waitcnt lgkmcnt(6)
    s_nop 0
    v_mfma_f32_16x16x32_bf16 v[32:35], v[44:47], v[192:195], v[32:35]
    ds_read_b128 v[204:207], v92 offset:448
    v_mfma_f32_16x16x32_bf16 v[28:31], v[44:47], v[176:179], 0
    buffer_load_dwordx4 a[184:187], v253, s[60:63], s81 offen offset:1024 sc1
    ds_read2_b32 v[56:57], v93 offset0:112 offset1:113
    ds_read2_b32 v[58:59], v93 offset0:114 offset1:115
    s_waitcnt lgkmcnt(6)
    s_nop 0
    v_mfma_f32_16x16x32_bf16 v[32:35], v[48:51], v[196:199], v[32:35]
    ds_read_b128 v[208:211], v92 offset:512
    v_mfma_f32_16x16x32_bf16 v[28:31], v[48:51], v[180:183], v[28:31]
    buffer_load_dwordx4 a[188:191], v253, s[60:63], s81 offen offset:2048 sc1
    ds_read2_b32 v[44:45], v93 offset0:128 offset1:129
    ds_read2_b32 v[46:47], v93 offset0:130 offset1:131
    s_waitcnt lgkmcnt(6)
    s_nop 0
    v_mfma_f32_16x16x32_bf16 v[32:35], v[52:55], v[200:203], v[32:35]
    buffer_load_dwordx4 a[192:195], v253, s[60:63], s81 offen offset:3072 sc1
    ds_read_b128 v[212:215], v92 offset:576
    v_mfma_f32_16x16x32_bf16 v[28:31], v[52:55], v[184:187], v[28:31]
    ds_read2_b32 v[48:49], v93 offset0:144 offset1:145
    ds_read2_b32 v[50:51], v93 offset0:146 offset1:147
    s_waitcnt lgkmcnt(6)
    s_nop 0
    v_mfma_f32_16x16x32_bf16 v[32:35], v[56:59], v[204:207], v[32:35]
    buffer_load_dwordx4 a[196:199], v252, s[60:63], s81 offen offset:3072 sc1
    ds_read_b128 v[216:219], v92 offset:640
    v_mfma_f32_16x16x32_bf16 v[28:31], v[56:59], v[188:191], v[28:31]
    ds_read2_b32 v[52:53], v93 offset0:160 offset1:161
    ds_read2_b32 v[54:55], v93 offset0:162 offset1:163
    s_waitcnt lgkmcnt(6)
    s_nop 0
    v_mfma_f32_16x16x32_bf16 v[32:35], v[44:47], v[208:211], v[32:35]
    s_add_u32 s81, s81, 40960
    ds_read_b128 v[220:223], v92 offset:704
    v_mfma_f32_16x16x32_bf16 v[28:31], v[44:47], v[192:195], v[28:31]
    ds_read2_b32 v[56:57], v93 offset0:176 offset1:177
    v_mfma_f32_16x16x32_bf16 v[24:27], v[44:47], v[176:179], 0
    buffer_load_dwordx4 a[200:203], v253, s[60:63], s81 offen offset:0 sc1
    ds_read2_b32 v[58:59], v93 offset0:178 offset1:179
    s_waitcnt lgkmcnt(6)
    s_nop 0
    v_mfma_f32_16x16x32_bf16 v[32:35], v[48:51], v[212:215], v[32:35]
    ds_read_b128 v[224:227], v92 offset:768
    v_mfma_f32_16x16x32_bf16 v[28:31], v[48:51], v[196:199], v[28:31]
    buffer_load_dwordx4 a[204:207], v253, s[60:63], s81 offen offset:1024 sc1
    ds_read2_b32 v[44:45], v93 offset0:192 offset1:193
    v_mfma_f32_16x16x32_bf16 v[24:27], v[48:51], v[180:183], v[24:27]
    buffer_load_dwordx4 a[208:211], v253, s[60:63], s81 offen offset:2048 sc1
    ds_read2_b32 v[46:47], v93 offset0:194 offset1:195
    s_waitcnt lgkmcnt(6)
    s_nop 0
    v_mfma_f32_16x16x32_bf16 v[32:35], v[52:55], v[216:219], v[32:35]
    ds_read_b128 v[228:231], v92 offset:832
    v_mfma_f32_16x16x32_bf16 v[28:31], v[52:55], v[200:203], v[28:31]
    buffer_load_dwordx4 a[212:215], v253, s[60:63], s81 offen offset:3072 sc1
    ds_read2_b32 v[48:49], v93 offset0:208 offset1:209
    v_mfma_f32_16x16x32_bf16 v[24:27], v[52:55], v[184:187], v[24:27]
    ds_read2_b32 v[50:51], v93 offset0:210 offset1:211
    s_waitcnt lgkmcnt(6)
    s_nop 0
    v_mfma_f32_16x16x32_bf16 v[32:35], v[56:59], v[220:223], v[32:35]
    buffer_load_dwordx4 a[216:219], v252, s[60:63], s81 offen offset:3072 sc1
    ds_read_b128 v[232:235], v92 offset:896
    v_mfma_f32_16x16x32_bf16 v[28:31], v[56:59], v[204:207], v[28:31]
    ds_read2_b32 v[52:53], v93 offset0:224 offset1:225
    v_mfma_f32_16x16x32_bf16 v[24:27], v[56:59], v[188:191], v[24:27]
    s_add_u32 s81, s81, 40960
    ds_read2_b32 v[54:55], v93 offset0:226 offset1:227
    s_waitcnt lgkmcnt(6)
    s_nop 0
    v_mfma_f32_16x16x32_bf16 v[32:35], v[44:47], v[224:227], v[32:35]
    ds_read_b128 v[236:239], v92 offset:960
    v_mfma_f32_16x16x32_bf16 v[28:31], v[44:47], v[208:211], v[28:31]
    buffer_load_dwordx4 a[220:223], v253, s[60:63], s81 offen offset:0 sc1
    ds_read2_b32 v[56:57], v93 offset0:240 offset1:241
    v_mfma_f32_16x16x32_bf16 v[24:27], v[44:47], v[192:195], v[24:27]
    buffer_load_dwordx4 a[224:227], v253, s[60:63], s81 offen offset:1024 sc1
    ds_read2_b32 v[58:59], v93 offset0:242 offset1:243
    v_mfma_f32_16x16x32_bf16 v[20:23], v[44:47], v[176:179], 0
    s_waitcnt lgkmcnt(6)
    s_nop 0
    v_mfma_f32_16x16x32_bf16 v[32:35], v[48:51], v[228:231], v[32:35]
    buffer_load_dwordx4 a[228:231], v253, s[60:63], s81 offen offset:2048 sc1
    ds_read_b128 v[176:179], v92 offset:1024
    v_mfma_f32_16x16x32_bf16 v[28:31], v[48:51], v[212:215], v[28:31]
    ds_read2_b32 v[44:45], v94 offset0:0 offset1:1
    v_mfma_f32_16x16x32_bf16 v[24:27], v[48:51], v[196:199], v[24:27]
    buffer_load_dwordx4 a[232:235], v253, s[60:63], s81 offen offset:3072 sc1
    ds_read2_b32 v[46:47], v94 offset0:2 offset1:3
    v_mfma_f32_16x16x32_bf16 v[20:23], v[48:51], v[180:183], v[20:23]
    s_waitcnt lgkmcnt(6)
    s_nop 0
    v_mfma_f32_16x16x32_bf16 v[32:35], v[52:55], v[232:235], v[32:35]
    buffer_load_dwordx4 a[236:239], v252, s[60:63], s81 offen offset:3072 sc1
    ds_read_b128 v[180:183], v92 offset:1088
    v_mfma_f32_16x16x32_bf16 v[28:31], v[52:55], v[216:219], v[28:31]
    ds_read2_b32 v[48:49], v94 offset0:16 offset1:17
    v_mfma_f32_16x16x32_bf16 v[24:27], v[52:55], v[200:203], v[24:27]
    s_waitcnt vmcnt(16)
    v_xor_b32 v62, s10, v62
    v_cmp_ne_u32 vcc, 0, v62
    ds_read2_b32 v[50:51], v94 offset0:18 offset1:19
    v_mfma_f32_16x16x32_bf16 v[20:23], v[52:55], v[184:187], v[20:23]
    s_cbranch_vccnz .Lhskipb0
    buffer_load_dwordx4 v[108:111], v253, s[60:63], s90 offen offset:0 sc1
.Lhskipb0:
    s_waitcnt lgkmcnt(6)
    s_nop 0
    v_mfma_f32_16x16x32_bf16 v[32:35], v[56:59], v[236:239], v[32:35]
    ds_read_b128 v[184:187], v92 offset:1152
    v_mfma_f32_16x16x32_bf16 v[28:31], v[56:59], v[220:223], v[28:31]
    ds_read2_b32 v[52:53], v94 offset0:32 offset1:33
    v_mfma_f32_16x16x32_bf16 v[24:27], v[56:59], v[204:207], v[24:27]
    ds_read2_b32 v[54:55], v94 offset0:34 offset1:35
    v_mfma_f32_16x16x32_bf16 v[20:23], v[56:59], v[188:191], v[20:23]
    v_add_u32 v92, 1024, v92
    v_add_u32 v93, 1056, v93
    v_add_u32 v94, 1056, v94
    s_waitcnt lgkmcnt(0)
.Lb3:
    s_nop 0
    v_cvt_pk_bf16_f32 v42, v32, v33
    v_cvt_pk_bf16_f32 v43, v34, v35
    v_cvt_pk_bf16_f32 v40, v28, v29
    v_cvt_pk_bf16_f32 v41, v30, v31
    v_cvt_pk_bf16_f32 v38, v24, v25
    v_cvt_pk_bf16_f32 v39, v26, v27
    v_cvt_pk_bf16_f32 v36, v20, v21
    v_cvt_pk_bf16_f32 v37, v22, v23
    v_mfma_f32_16x16x32_bf16 v[32:35], v[44:47], v[176:179], v[32:35]
    ds_read_b128 v[188:191], v92 offset:192
    v_mfma_f32_16x16x32_bf16 v[28:31], v[44:47], v[224:227], v[28:31]
    ds_read2_b32 v[56:57], v93 offset0:48 offset1:49
    v_mfma_f32_16x16x32_bf16 v[24:27], v[44:47], v[208:211], v[24:27]
    s_cbranch_vccnz .Lhs
.Lhb:
    s_nop 0
    ds_read2_b32 v[58:59], v93 offset0:50 offset1:51
    v_mfma_f32_16x16x32_bf16 v[20:23], v[44:47], v[192:195], v[20:23]
    buffer_load_dwordx4 v[112:115], v253, s[60:63], s90 offen offset:1024 sc1
    v_mfma_f32_16x16x32_bf16 v[32:35], v[48:51], v[180:183], v[32:35]
    ds_read_b64 v[4:5], v98 offset:0
    ds_read_b128 v[192:195], v92 offset:256
    v_mfma_f32_16x16x32_bf16 v[28:31], v[48:51], v[228:231], v[28:31]
    ds_read2_b32 v[44:45], v93 offset0:64 offset1:65
    v_mfma_f32_16x16x32_bf16 v[24:27], v[48:51], v[212:215], v[24:27]
    buffer_load_dwordx4 v[116:119], v253, s[60:63], s90 offen offset:2048 sc1
    ds_read2_b32 v[46:47], v93 offset0:66 offset1:67
    v_mfma_f32_16x16x32_bf16 v[20:23], v[48:51], v[196:199], v[20:23]
    v_mfma_f32_16x16x32_bf16 v[32:35], v[52:55], v[184:187], v[32:35]
    ds_read_b128 v[196:199], v92 offset:320
    v_mfma_f32_16x16x32_bf16 v[28:31], v[52:55], v[232:235], v[28:31]
    buffer_load_dwordx4 v[120:123], v253, s[60:63], s90 offen offset:3072 sc1
    ds_read2_b32 v[48:49], v93 offset0:80 offset1:81
    v_mfma_f32_16x16x32_bf16 v[24:27], v[52:55], v[216:219], v[24:27]
    ds_read_b64 v[14:15], v99 offset:3072
    ds_read2_b32 v[50:51], v93 offset0:82 offset1:83
    v_mfma_f32_16x16x32_bf16 v[20:23], v[52:55], v[200:203], v[20:23]
    s_waitcnt lgkmcnt(8)
    s_nop 0
    v_mfma_f32_16x16x32_bf16 v[32:35], v[56:59], v[188:191], v[32:35]
    buffer_load_dwordx4 v[124:127], v254, s[60:63], s90 offen offset:0 sc1
    ds_read_b128 v[200:203], v92 offset:384
    v_mfma_f32_16x16x32_bf16 v[28:31], v[56:59], v[236:239], v[28:31]
    ds_read2_b32 v[52:53], v93 offset0:96 offset1:97
    v_mfma_f32_16x16x32_bf16 v[24:27], v[56:59], v[220:223], v[24:27]
    ds_read2_b32 v[54:55], v93 offset0:98 offset1:99
    v_mfma_f32_16x16x32_bf16 v[20:23], v[56:59], v[204:207], v[20:23]
    buffer_load_dwordx4 v[128:131], v254, s[60:63], s90 offen offset:1024 sc1
    s_waitcnt lgkmcnt(7)
    s_nop 0
    v_mfma_f32_16x16x32_bf16 v[32:35], v[44:47], v[192:195], v[32:35]
    ds_read_b64 v[6:7], v98 offset:32
    ds_read_b128 v[204:207], v92 offset:448
    v_mfma_f32_16x16x32_bf16 v[28:31], v[44:47], v[176:179], v[28:31]
    ds_read2_b32 v[56:57], v93 offset0:112 offset1:113
    v_mfma_f32_16x16x32_bf16 v[24:27], v[44:47], v[224:227], v[24:27]
    buffer_load_dwordx4 v[132:135], v254, s[60:63], s18 offen offset:2048 sc1
    ds_read2_b32 v[58:59], v93 offset0:114 offset1:115
    v_mfma_f32_16x16x32_bf16 v[20:23], v[44:47], v[208:211], v[20:23]
    s_waitcnt lgkmcnt(7)
    s_nop 0
    v_mfma_f32_16x16x32_bf16 v[32:35], v[48:51], v[196:199], v[32:35]
    ds_read_b128 v[208:211], v92 offset:512
    v_mfma_f32_16x16x32_bf16 v[28:31], v[48:51], v[180:183], v[28:31]
    buffer_load_dwordx4 v[136:139], v254, s[60:63], s18 offen offset:3072 sc1
    ds_read2_b32 v[44:45], v93 offset0:128 offset1:129
    v_mfma_f32_16x16x32_bf16 v[24:27], v[48:51], v[228:231], v[24:27]
    ds_read_b64 v[16:17], v99 offset:3584
    ds_read2_b32 v[46:47], v93 offset0:130 offset1:131
    v_mfma_f32_16x16x32_bf16 v[20:23], v[48:51], v[212:215], v[20:23]
    s_waitcnt lgkmcnt(8)
    s_nop 0
    v_mfma_f32_16x16x32_bf16 v[32:35], v[52:55], v[200:203], v[32:35]
    buffer_load_dwordx4 v[140:143], v255, s[60:63], s18 offen offset:0 sc1
    ds_read_b128 v[212:215], v92 offset:576
    v_mfma_f32_16x16x32_bf16 v[28:31], v[52:55], v[184:187], v[28:31]
    ds_read2_b32 v[48:49], v93 offset0:144 offset1:145
    v_mfma_f32_16x16x32_bf16 v[24:27], v[52:55], v[232:235], v[24:27]
    ds_read2_b32 v[50:51], v93 offset0:146 offset1:147
    v_mfma_f32_16x16x32_bf16 v[20:23], v[52:55], v[216:219], v[20:23]
    buffer_load_dwordx4 v[144:147], v255, s[60:63], s18 offen offset:1024 sc1
    s_waitcnt lgkmcnt(7)
    s_nop 0
    v_mfma_f32_16x16x32_bf16 v[32:35], v[56:59], v[204:207], v[32:35]
    ds_read_b64 v[8:9], v98 offset:64
    ds_read_b128 v[216:219], v92 offset:640
    v_mfma_f32_16x16x32_bf16 v[28:31], v[56:59], v[188:191], v[28:31]
    ds_read2_b32 v[52:53], v93 offset0:160 offset1:161
    v_mfma_f32_16x16x32_bf16 v[24:27], v[56:59], v[236:239], v[24:27]
    buffer_load_dwordx4 v[148:151], v255, s[60:63], s18 offen offset:2048 sc1
    ds_read2_b32 v[54:55], v93 offset0:162 offset1:163
    v_mfma_f32_16x16x32_bf16 v[20:23], v[56:59], v[220:223], v[20:23]
    s_waitcnt lgkmcnt(7)
    s_nop 0
    v_mfma_f32_16x16x32_bf16 v[32:35], v[44:47], v[208:211], v[32:35]
    ds_read_b128 v[220:223], v92 offset:704
    v_mfma_f32_16x16x32_bf16 v[28:31], v[44:47], v[192:195], v[28:31]
    buffer_load_dwordx4 v[152:155], v255, s[60:63], s18 offen offset:3072 sc1
    ds_read2_b32 v[56:57], v93 offset0:176 offset1:177
    v_mfma_f32_16x16x32_bf16 v[24:27], v[44:47], v[176:179], v[24:27]
    ds_read_b64 v[18:19], v99 offset:4096
    ds_read2_b32 v[58:59], v93 offset0:178 offset1:179
    v_mfma_f32_16x16x32_bf16 v[20:23], v[44:47], v[224:227], v[20:23]
    s_waitcnt lgkmcnt(8)
    s_nop 0
    v_mfma_f32_16x16x32_bf16 v[32:35], v[48:51], v[212:215], v[32:35]
    buffer_load_dwordx4 v[156:159], v253, s[60:63], s91 offen offset:0 sc1
    ds_read_b128 v[224:227], v92 offset:768
    v_mfma_f32_16x16x32_bf16 v[28:31], v[48:51], v[196:199], v[28:31]
    ds_read2_b32 v[44:45], v93 offset0:192 offset1:193
    v_mfma_f32_16x16x32_bf16 v[24:27], v[48:51], v[180:183], v[24:27]
    ds_read2_b32 v[46:47], v93 offset0:194 offset1:195
    v_mfma_f32_16x16x32_bf16 v[20:23], v[48:51], v[228:231], v[20:23]
    buffer_load_dwordx4 v[160:163], v253, s[60:63], s91 offen offset:1024 sc1
    s_waitcnt lgkmcnt(7)
    s_nop 0
    v_mfma_f32_16x16x32_bf16 v[32:35], v[52:55], v[216:219], v[32:35]
    ds_read_b64 v[10:11], v98 offset:96
    ds_read_b128 v[228:231], v92 offset:832
    v_mfma_f32_16x16x32_bf16 v[28:31], v[52:55], v[200:203], v[28:31]
    ds_read2_b32 v[48:49], v93 offset0:208 offset1:209
    v_mfma_f32_16x16x32_bf16 v[24:27], v[52:55], v[184:187], v[24:27]
    buffer_load_dwordx4 v[164:167], v253, s[60:63], s91 offen offset:2048 sc1
    ds_read2_b32 v[50:51], v93 offset0:210 offset1:211
    v_mfma_f32_16x16x32_bf16 v[20:23], v[52:55], v[232:235], v[20:23]
    s_waitcnt lgkmcnt(7)
    s_nop 0
    v_mfma_f32_16x16x32_bf16 v[32:35], v[56:59], v[220:223], v[32:35]
    ds_read_b128 v[232:235], v92 offset:896
    v_mfma_f32_16x16x32_bf16 v[28:31], v[56:59], v[204:207], v[28:31]
    buffer_load_dwordx4 v[168:171], v253, s[60:63], s91 offen offset:3072 sc1
    ds_read2_b32 v[52:53], v93 offset0:224 offset1:225
    v_mfma_f32_16x16x32_bf16 v[24:27], v[56:59], v[188:191], v[24:27]
    ds_read_b64 v[88:89], v99 offset:4608
    ds_read2_b32 v[54:55], v93 offset0:226 offset1:227
    v_mfma_f32_16x16x32_bf16 v[20:23], v[56:59], v[236:239], v[20:23]
    s_waitcnt lgkmcnt(8)
    s_nop 0
    v_mfma_f32_16x16x32_bf16 v[32:35], v[44:47], v[224:227], v[32:35]
    buffer_load_dwordx4 v[172:175], v254, s[60:63], s91 offen offset:0 sc1
    ds_read_b128 v[236:239], v92 offset:960
    v_mfma_f32_16x16x32_bf16 v[28:31], v[44:47], v[208:211], v[28:31]
    ds_read2_b32 v[56:57], v93 offset0:240 offset1:241
    v_mfma_f32_16x16x32_bf16 v[24:27], v[44:47], v[192:195], v[24:27]
    ds_read2_b32 v[58:59], v93 offset0:242 offset1:243
    v_mfma_f32_16x16x32_bf16 v[20:23], v[44:47], v[176:179], v[20:23]
    s_waitcnt lgkmcnt(7)
    s_nop 0
    v_mfma_f32_16x16x32_bf16 v[32:35], v[48:51], v[228:231], v[32:35]
    ds_read_b64 v[12:13], v98 offset:128
    v_mfma_f32_16x16x32_bf16 v[28:31], v[48:51], v[212:215], v[28:31]
    v_mfma_f32_16x16x32_bf16 v[24:27], v[48:51], v[196:199], v[24:27]
    v_mfma_f32_16x16x32_bf16 v[20:23], v[48:51], v[180:183], v[20:23]
    s_waitcnt lgkmcnt(4)
    s_nop 0
    v_mfma_f32_16x16x32_bf16 v[32:35], v[52:55], v[232:235], v[32:35]
    v_mfma_f32_16x16x32_bf16 v[28:31], v[52:55], v[216:219], v[28:31]
    v_mfma_f32_16x16x32_bf16 v[24:27], v[52:55], v[200:203], v[24:27]
    ds_read_b64 v[90:91], v99 offset:5120
    v_mfma_f32_16x16x32_bf16 v[20:23], v[52:55], v[184:187], v[20:23]
    s_waitcnt lgkmcnt(2)
    v_mfma_f32_16x16x32_bf16 v[32:35], v[56:59], v[236:239], v[32:35]
    v_mfma_f32_16x16x32_bf16 v[28:31], v[56:59], v[220:223], v[28:31]
    v_mfma_f32_16x16x32_bf16 v[24:27], v[56:59], v[204:207], v[24:27]
    v_mfma_f32_16x16x32_bf16 v[20:23], v[56:59], v[188:191], v[20:23]
    s_mov_b32 exec_lo, 0
    s_nop 3
    s_nop 0
    v_cvt_pk_bf16_f32 v42, v32, v33
    v_cvt_pk_bf16_f32 v43, v34, v35
    v_cvt_pk_bf16_f32 v40, v28, v29
    v_cvt_pk_bf16_f32 v41, v30, v31
    v_cvt_pk_bf16_f32 v38, v24, v25
    v_cvt_pk_bf16_f32 v39, v26, v27
    v_cvt_pk_bf16_f32 v36, v20, v21
    v_cvt_pk_bf16_f32 v37, v22, v23
    s_mov_b32 exec_lo, -1
    v_permlane16_swap_b32 v36, v38
    v_permlane16_swap_b32 v37, v39
    buffer_store_dwordx4 v[36:39], v103, s[60:63], s74 offen offset:0 sc0 sc1
    v_permlane16_swap_b32 v40, v42
    v_permlane16_swap_b32 v41, v43
    buffer_store_dwordx4 v[40:43], v103, s[60:63], s74 offen offset:512 sc0 sc1
    v_add_u32 v240, s79, v253
    s_waitcnt vmcnt(18)
    v_mfma_f32_16x16x32_bf16 v[20:23], a[0:3], v[108:111], 0
    v_mfma_f32_16x16x32_bf16 v[24:27], a[4:7], v[108:111], 0
    s_lshl_b32 s11, s7, 12
    s_add_u32 s11, s11, 22282240
    v_mfma_f32_16x16x32_bf16 v[28:31], a[8:11], v[108:111], 0
    v_and_b32 v2, 31, v0
    v_mfma_f32_16x16x32_bf16 v[32:35], a[12:15], v[108:111], 0
    v_lshl_add_u32 v64, v2, 7, s11
    v_mfma_f32_16x16x32_bf16 v[36:39], a[16:19], v[108:111], 0
    s_waitcnt vmcnt(17)
    v_mfma_f32_16x16x32_bf16 v[20:23], a[20:23], v[112:115], v[20:23]
    v_lshrrev_b32 v65, 2, v0
    v_mfma_f32_16x16x32_bf16 v[24:27], a[24:27], v[112:115], v[24:27]
    v_lshlrev_b32 v65, 7, v65
    v_mfma_f32_16x16x32_bf16 v[28:31], a[28:31], v[112:115], v[28:31]
    v_and_b32 v1, 3, v0
    v_lshl_add_u32 v65, v1, 3, v65
    v_mfma_f32_16x16x32_bf16 v[32:35], a[32:35], v[112:115], v[32:35]
    s_lshl_b32 s11, s84, 5
    v_mfma_f32_16x16x32_bf16 v[36:39], a[36:39], v[112:115], v[36:39]
    s_waitcnt vmcnt(16)
    v_mfma_f32_16x16x32_bf16 v[20:23], a[40:43], v[116:119], v[20:23]
    s_add_u32 s11, s11, 126976
    v_mfma_f32_16x16x32_bf16 v[24:27], a[44:47], v[116:119], v[24:27]
    v_add_u32 v65, s11, v65
    v_mfma_f32_16x16x32_bf16 v[28:31], a[48:51], v[116:119], v[28:31]
    v_lshlrev_b32 v216, 16, v78
    v_mfma_f32_16x16x32_bf16 v[32:35], a[52:55], v[116:119], v[32:35]
    v_and_b32 v217, 0xffff0000, v78
    v_lshlrev_b32 v218, 16, v79
    v_mfma_f32_16x16x32_bf16 v[36:39], a[56:59], v[116:119], v[36:39]
    s_waitcnt vmcnt(15)
    v_mfma_f32_16x16x32_bf16 v[20:23], a[60:63], v[120:123], v[20:23]
    v_and_b32 v219, 0xffff0000, v79
    v_mfma_f32_16x16x32_bf16 v[24:27], a[64:67], v[120:123], v[24:27]
    v_lshlrev_b32 v220, 16, v80
    v_mfma_f32_16x16x32_bf16 v[28:31], a[68:71], v[120:123], v[28:31]
    v_and_b32 v221, 0xffff0000, v80
    v_mfma_f32_16x16x32_bf16 v[32:35], a[72:75], v[120:123], v[32:35]
    v_lshlrev_b32 v222, 16, v81
    v_mfma_f32_16x16x32_bf16 v[36:39], a[76:79], v[120:123], v[36:39]
    v_and_b32 v223, 0xffff0000, v81
    s_waitcnt vmcnt(14)
    v_mfma_f32_16x16x32_bf16 v[20:23], a[80:83], v[124:127], v[20:23]
    v_lshlrev_b32 v224, 16, v82
    v_mfma_f32_16x16x32_bf16 v[24:27], a[84:87], v[124:127], v[24:27]
    v_and_b32 v225, 0xffff0000, v82
    v_mfma_f32_16x16x32_bf16 v[28:31], a[88:91], v[124:127], v[28:31]
    v_lshlrev_b32 v226, 16, v83
    v_mfma_f32_16x16x32_bf16 v[32:35], a[92:95], v[124:127], v[32:35]
    v_and_b32 v227, 0xffff0000, v83
    v_mfma_f32_16x16x32_bf16 v[36:39], a[96:99], v[124:127], v[36:39]
    v_lshlrev_b32 v228, 16, v84
    s_waitcnt vmcnt(13)
    v_mfma_f32_16x16x32_bf16 v[20:23], a[100:103], v[128:131], v[20:23]
    buffer_load_dwordx4 v[108:111], v254, s[60:63], s91 offen offset:1024 sc1
    v_mfma_f32_16x16x32_bf16 v[24:27], a[104:107], v[128:131], v[24:27]
    v_and_b32 v229, 0xffff0000, v84
    v_lshlrev_b32 v230, 16, v85
    v_mfma_f32_16x16x32_bf16 v[28:31], a[108:111], v[128:131], v[28:31]
    v_and_b32 v231, 0xffff0000, v85
    v_mfma_f32_16x16x32_bf16 v[32:35], a[112:115], v[128:131], v[32:35]
    v_lshlrev_b32 v232, 16, v86
    v_mfma_f32_16x16x32_bf16 v[36:39], a[116:119], v[128:131], v[36:39]
    s_waitcnt vmcnt(13)
    v_mfma_f32_16x16x32_bf16 v[20:23], a[120:123], v[132:135], v[20:23]
    v_and_b32 v233, 0xffff0000, v86
    buffer_load_dwordx4 v[112:115], v254, s[60:63], s19 offen offset:2048 sc1
    v_mfma_f32_16x16x32_bf16 v[24:27], a[124:127], v[132:135], v[24:27]
    v_lshlrev_b32 v234, 16, v87
    v_mfma_f32_16x16x32_bf16 v[28:31], a[128:131], v[132:135], v[28:31]
    v_and_b32 v235, 0xffff0000, v87
    v_mfma_f32_16x16x32_bf16 v[32:35], a[132:135], v[132:135], v[32:35]
    v_lshlrev_b32 v92, 16, v4
    v_mfma_f32_16x16x32_bf16 v[36:39], a[136:139], v[132:135], v[36:39]
    v_and_b32 v93, 0xffff0000, v4
    s_waitcnt vmcnt(13)
    v_mfma_f32_16x16x32_bf16 v[20:23], a[140:143], v[136:139], v[20:23]
    buffer_load_dwordx4 v[116:119], v254, s[60:63], s19 offen offset:3072 sc1
    v_mfma_f32_16x16x32_bf16 v[24:27], a[144:147], v[136:139], v[24:27]
    v_lshlrev_b32 v100, 16, v5
    v_mfma_f32_16x16x32_bf16 v[28:31], a[148:151], v[136:139], v[28:31]
    v_and_b32 v101, 0xffff0000, v5
    v_mfma_f32_16x16x32_bf16 v[32:35], a[152:155], v[136:139], v[32:35]
    v_lshlrev_b32 v102, 16, v6
    v_mfma_f32_16x16x32_bf16 v[36:39], a[156:159], v[136:139], v[36:39]
    v_and_b32 v103, 0xffff0000, v6
    s_waitcnt vmcnt(13)
    v_mfma_f32_16x16x32_bf16 v[20:23], a[160:163], v[140:143], v[20:23]
    v_lshlrev_b32 v244, 16, v7
    buffer_load_dwordx4 v[120:123], v255, s[60:63], s19 offen offset:0 sc1
    v_mfma_f32_16x16x32_bf16 v[24:27], a[164:167], v[140:143], v[24:27]
    v_and_b32 v245, 0xffff0000, v7
    v_mfma_f32_16x16x32_bf16 v[28:31], a[168:171], v[140:143], v[28:31]
    v_lshlrev_b32 v246, 16, v8
    v_mfma_f32_16x16x32_bf16 v[32:35], a[172:175], v[140:143], v[32:35]
    v_and_b32 v247, 0xffff0000, v8
    v_mfma_f32_16x16x32_bf16 v[36:39], a[176:179], v[140:143], v[36:39]
    s_waitcnt vmcnt(13)
    v_mfma_f32_16x16x32_bf16 v[20:23], a[180:183], v[144:147], v[20:23]
    v_lshlrev_b32 v78, 16, v9
    buffer_load_dwordx4 v[124:127], v255, s[60:63], s19 offen offset:1024 sc1
    v_mfma_f32_16x16x32_bf16 v[24:27], a[184:187], v[144:147], v[24:27]
    v_and_b32 v79, 0xffff0000, v9
    v_mfma_f32_16x16x32_bf16 v[28:31], a[188:191], v[144:147], v[28:31]
    v_lshlrev_b32 v80, 16, v10
    v_mfma_f32_16x16x32_bf16 v[32:35], a[192:195], v[144:147], v[32:35]
    v_and_b32 v81, 0xffff0000, v10
    v_mfma_f32_16x16x32_bf16 v[36:39], a[196:199], v[144:147], v[36:39]
    v_lshlrev_b32 v82, 16, v11
    s_waitcnt vmcnt(13)
    v_mfma_f32_16x16x32_bf16 v[20:23], a[200:203], v[148:151], v[20:23]
    s_waitcnt vmcnt(5)
    s_nop 0
    buffer_store_dword v241, v242, s[60:63], s75 offen sc0 sc1
    buffer_load_dwordx4 v[128:131], v255, s[60:63], s19 offen offset:2048 sc1
    v_mfma_f32_16x16x32_bf16 v[24:27], a[204:207], v[148:151], v[24:27]
    v_and_b32 v83, 0xffff0000, v11
    v_mfma_f32_16x16x32_bf16 v[28:31], a[208:211], v[148:151], v[28:31]
    s_waitcnt lgkmcnt(1)
    v_lshlrev_b32 v84, 16, v12
    v_mfma_f32_16x16x32_bf16 v[32:35], a[212:215], v[148:151], v[32:35]
    v_and_b32 v85, 0xffff0000, v12
    v_mfma_f32_16x16x32_bf16 v[36:39], a[216:219], v[148:151], v[36:39]
    v_lshlrev_b32_e64 v86, 16, v13
    v_mfma_f32_16x16x32_bf16 v[20:23], a[220:223], v[152:155], v[20:23]
    buffer_load_dwordx4 v[132:135], v255, s[60:63], s19 offen offset:3072 sc1
    v_mfma_f32_16x16x32_bf16 v[24:27], a[224:227], v[152:155], v[24:27]
    v_and_b32 v87, 0xffff0000, v13
    v_mfma_f32_16x16x32_bf16 v[28:31], a[228:231], v[152:155], v[28:31]
    s_mul_i32 s11, s3, 6144
    v_mfma_f32_16x16x32_bf16 v[32:35], a[232:235], v[152:155], v[32:35]
    s_add_u32 s11, s11, 102400
    v_mfma_f32_16x16x32_bf16 v[36:39], a[236:239], v[152:155], v[36:39]
    v_add_u32 v104, s11, v253
    v_mfma_f32_16x16x32_bf16 v[176:179], a[0:3], v[156:159], 0
    buffer_load_dwordx4 v[136:139], v253, s[60:63], s92 offen offset:0 sc1
    v_mfma_f32_16x16x32_bf16 v[180:183], a[4:7], v[156:159], 0
    s_sub_u32 s11, s3, 1
    s_and_b32 s11, s11, 3
    s_nop 0
    v_mfma_f32_16x16x32_bf16 v[184:187], a[8:11], v[156:159], 0
    ds_write_b128 v240, v[20:23] offset:0
    v_mfma_f32_16x16x32_bf16 v[188:191], a[12:15], v[156:159], 0
    s_mul_i32 s11, s11, 15360
    v_mfma_f32_16x16x32_bf16 v[192:195], a[16:19], v[156:159], 0
    s_add_u32 s11, s11, 40960
    v_mfma_f32_16x16x32_bf16 v[176:179], a[20:23], v[160:163], v[176:179]
    buffer_load_dwordx4 v[140:143], v253, s[60:63], s92 offen offset:1024 sc1
    v_mfma_f32_16x16x32_bf16 v[180:183], a[24:27], v[160:163], v[180:183]
    ds_write_b128 v240, v[24:27] offset:1024
    v_add_u32 v66, s11, v253
    v_mfma_f32_16x16x32_bf16 v[184:187], a[28:31], v[160:163], v[184:187]
    s_sub_u32 s11, s3, 2
    v_mfma_f32_16x16x32_bf16 v[188:191], a[32:35], v[160:163], v[188:191]
    s_and_b32 s11, s11, 3
    s_nop 0
    v_mfma_f32_16x16x32_bf16 v[192:195], a[36:39], v[160:163], v[192:195]
    s_mul_i32 s11, s11, 15360
    v_mfma_f32_16x16x32_bf16 v[176:179], a[40:43], v[164:167], v[176:179]
    ds_write_b128 v240, v[28:31] offset:2048
    buffer_load_dwordx4 v[144:147], v253, s[60:63], s92 offen offset:2048 sc1
    v_mfma_f32_16x16x32_bf16 v[180:183], a[44:47], v[164:167], v[180:183]
    s_add_u32 s11, s11, 40960
    v_mfma_f32_16x16x32_bf16 v[184:187], a[48:51], v[164:167], v[184:187]
    v_add_u32 v67, s11, v253
    v_mfma_f32_16x16x32_bf16 v[188:191], a[52:55], v[164:167], v[188:191]
    s_sub_u32 s11, s3, 3
    v_mfma_f32_16x16x32_bf16 v[192:195], a[56:59], v[164:167], v[192:195]
    ds_write_b128 v240, v[32:35] offset:3072
    v_mfma_f32_16x16x32_bf16 v[176:179], a[60:63], v[168:171], v[176:179]
    buffer_load_dwordx4 v[148:151], v253, s[60:63], s92 offen offset:3072 sc1
    v_mfma_f32_16x16x32_bf16 v[180:183], a[64:67], v[168:171], v[180:183]
    s_and_b32 s11, s11, 3
    s_nop 0
    v_mfma_f32_16x16x32_bf16 v[184:187], a[68:71], v[168:171], v[184:187]
    s_mul_i32 s11, s11, 15360
    s_add_u32 s11, s11, 40960
    v_mfma_f32_16x16x32_bf16 v[188:191], a[72:75], v[168:171], v[188:191]
    ds_write_b128 v240, v[36:39] offset:4096
    v_mfma_f32_16x16x32_bf16 v[192:195], a[76:79], v[168:171], v[192:195]
    v_add_u32_e64 v1, s11, v253
    v_mfma_f32_16x16x32_bf16 v[176:179], a[80:83], v[172:175], v[176:179]
    buffer_load_dwordx4 v[152:155], v254, s[60:63], s92 offen offset:0 sc1
    v_mfma_f32_16x16x32_bf16 v[180:183], a[84:87], v[172:175], v[180:183]
    s_mov_b32 s12, 3216550459
    v_mfma_f32_16x16x32_bf16 v[184:187], a[88:91], v[172:175], v[184:187]
    s_mov_b32 s13, 3216550459
    v_mfma_f32_16x16x32_bf16 v[188:191], a[92:95], v[172:175], v[188:191]
    s_mov_b32 s14, 1.0
    v_mfma_f32_16x16x32_bf16 v[192:195], a[96:99], v[172:175], v[192:195]
    s_mov_b32 s15, 1.0
    s_waitcnt vmcnt(12)
    s_nop 0
    v_mfma_f32_16x16x32_bf16 v[176:179], a[100:103], v[108:111], v[176:179]
    buffer_load_dwordx4 v[156:159], v254, s[60:63], s92 offen offset:1024 sc1
    v_mfma_f32_16x16x32_bf16 v[180:183], a[104:107], v[108:111], v[180:183]
    v_mfma_f32_16x16x32_bf16 v[184:187], a[108:111], v[108:111], v[184:187]
    v_mfma_f32_16x16x32_bf16 v[188:191], a[112:115], v[108:111], v[188:191]
    v_mfma_f32_16x16x32_bf16 v[192:195], a[116:119], v[108:111], v[192:195]
    s_waitcnt vmcnt(12)
    v_mfma_f32_16x16x32_bf16 v[176:179], a[120:123], v[112:115], v[176:179]
    v_lshlrev_b32 v2, 16, v14
    buffer_load_dwordx4 v[160:163], v254, s[60:63], s20 offen offset:2048 sc1
    v_mfma_f32_16x16x32_bf16 v[180:183], a[124:127], v[112:115], v[180:183]
    v_lshlrev_b32_e64 v3, 16, v68
    v_mfma_f32_16x16x32_bf16 v[184:187], a[128:131], v[112:115], v[184:187]
    v_and_b32 v238, 0xffff0000, v14
    v_mfma_f32_16x16x32_bf16 v[188:191], a[132:135], v[112:115], v[188:191]
    v_and_b32 v239, 0xffff0000, v68
    v_mfma_f32_16x16x32_bf16 v[192:195], a[136:139], v[112:115], v[192:195]
    v_mul_f32 v14, v2, v3
    s_waitcnt vmcnt(12)
    v_mfma_f32_16x16x32_bf16 v[176:179], a[140:143], v[116:119], v[176:179]
    buffer_load_dwordx4 v[164:167], v254, s[60:63], s20 offen offset:3072 sc1
    v_mfma_f32_16x16x32_bf16 v[180:183], a[144:147], v[116:119], v[180:183]
    v_mul_f32 v68, v238, v239
    v_lshlrev_b32 v2, 16, v15
    v_mfma_f32_16x16x32_bf16 v[184:187], a[148:151], v[116:119], v[184:187]
    v_lshlrev_b32 v3, 16, v69
    v_mfma_f32_16x16x32_bf16 v[188:191], a[152:155], v[116:119], v[188:191]
    v_and_b32 v238, 0xffff0000, v15
    v_mfma_f32_16x16x32_bf16 v[192:195], a[156:159], v[116:119], v[192:195]
    s_waitcnt vmcnt(12)
    v_mfma_f32_16x16x32_bf16 v[176:179], a[160:163], v[120:123], v[176:179]
    v_and_b32 v239, 0xffff0000, v69
    buffer_load_dwordx4 v[168:171], v255, s[60:63], s20 offen offset:0 sc1
    v_mfma_f32_16x16x32_bf16 v[180:183], a[164:167], v[120:123], v[180:183]
    v_mul_f32 v15, v2, v3
    v_mfma_f32_16x16x32_bf16 v[184:187], a[168:171], v[120:123], v[184:187]
    v_mul_f32 v69, v238, v239
    v_mfma_f32_16x16x32_bf16 v[188:191], a[172:175], v[120:123], v[188:191]
    v_lshlrev_b32 v2, 16, v16
    v_mfma_f32_16x16x32_bf16 v[192:195], a[176:179], v[120:123], v[192:195]
    v_lshlrev_b32 v3, 16, v70
    s_waitcnt vmcnt(12)
    s_nop 0
    v_mfma_f32_16x16x32_bf16 v[176:179], a[180:183], v[124:127], v[176:179]
    buffer_load_dwordx4 v[172:175], v255, s[60:63], s20 offen offset:1024 sc1
    v_mfma_f32_16x16x32_bf16 v[180:183], a[184:187], v[124:127], v[180:183]
    v_and_b32 v238, 0xffff0000, v16
    v_mfma_f32_16x16x32_bf16 v[184:187], a[188:191], v[124:127], v[184:187]
    v_and_b32 v239, 0xffff0000, v70
    v_mul_f32 v16, v2, v3
    v_mfma_f32_16x16x32_bf16 v[188:191], a[192:195], v[124:127], v[188:191]
    v_mul_f32 v70, v238, v239
    v_mfma_f32_16x16x32_bf16 v[192:195], a[196:199], v[124:127], v[192:195]
    s_waitcnt vmcnt(11)
    v_mfma_f32_16x16x32_bf16 v[176:179], a[200:203], v[128:131], v[176:179]
    v_lshlrev_b32 v2, 16, v17
    buffer_load_dwordx4 v[108:111], v255, s[60:63], s20 offen offset:2048 sc1
    v_mfma_f32_16x16x32_bf16 v[180:183], a[204:207], v[128:131], v[180:183]
    v_lshlrev_b32_e64 v3, 16, v71
    v_mfma_f32_16x16x32_bf16 v[184:187], a[208:211], v[128:131], v[184:187]
    v_and_b32 v238, 0xffff0000, v17
    v_mfma_f32_16x16x32_bf16 v[188:191], a[212:215], v[128:131], v[188:191]
    v_and_b32 v239, 0xffff0000, v71
    v_mfma_f32_16x16x32_bf16 v[192:195], a[216:219], v[128:131], v[192:195]
    v_mul_f32 v17, v2, v3
    s_waitcnt vmcnt(11)
    v_mfma_f32_16x16x32_bf16 v[176:179], a[220:223], v[132:135], v[176:179]
    buffer_load_dwordx4 v[112:115], v255, s[60:63], s20 offen offset:3072 sc1
    v_mfma_f32_16x16x32_bf16 v[180:183], a[224:227], v[132:135], v[180:183]
    v_mul_f32 v71, v238, v239
    v_mfma_f32_16x16x32_bf16 v[184:187], a[228:231], v[132:135], v[184:187]
    v_lshlrev_b32 v2, 16, v18
    v_mfma_f32_16x16x32_bf16 v[188:191], a[232:235], v[132:135], v[188:191]
    v_lshlrev_b32 v3, 16, v72
    v_and_b32 v238, 0xffff0000, v18
    v_mfma_f32_16x16x32_bf16 v[192:195], a[236:239], v[132:135], v[192:195]
    s_waitcnt vmcnt(11)
    v_mfma_f32_16x16x32_bf16 v[196:199], a[0:3], v[136:139], 0
    v_and_b32 v239, 0xffff0000, v72
    buffer_load_dwordx4 v[116:119], v253, s[60:63], s93 offen offset:0 sc1
    v_mfma_f32_16x16x32_bf16 v[200:203], a[4:7], v[136:139], 0
    v_mul_f32 v18, v2, v3
    v_mfma_f32_16x16x32_bf16 v[204:207], a[8:11], v[136:139], 0
    ds_write_b128 v240, v[176:179] offset:5120
    v_mfma_f32_16x16x32_bf16 v[208:211], a[12:15], v[136:139], 0
    v_mul_f32 v72, v238, v239
    v_mfma_f32_16x16x32_bf16 v[212:215], a[16:19], v[136:139], 0
    v_lshlrev_b32 v2, 16, v19
    s_waitcnt vmcnt(11)
    v_mfma_f32_16x16x32_bf16 v[196:199], a[20:23], v[140:143], v[196:199]
    v_lshlrev_b32_e64 v3, 16, v73
    buffer_load_dwordx4 v[120:123], v253, s[60:63], s93 offen offset:1024 sc1
    v_mfma_f32_16x16x32_bf16 v[200:203], a[24:27], v[140:143], v[200:203]
    ds_write_b128 v240, v[180:183] offset:6144
    v_mfma_f32_16x16x32_bf16 v[204:207], a[28:31], v[140:143], v[204:207]
    v_and_b32 v238, 0xffff0000, v19
    v_mfma_f32_16x16x32_bf16 v[208:211], a[32:35], v[140:143], v[208:211]
    v_and_b32 v239, 0xffff0000, v73
    v_mfma_f32_16x16x32_bf16 v[212:215], a[36:39], v[140:143], v[212:215]
    v_mul_f32 v19, v2, v3
    s_waitcnt vmcnt(11)
    v_mfma_f32_16x16x32_bf16 v[196:199], a[40:43], v[144:147], v[196:199]
    ds_write_b128 v240, v[184:187] offset:7168
    buffer_load_dwordx4 v[124:127], v253, s[60:63], s93 offen offset:2048 sc1
    v_mfma_f32_16x16x32_bf16 v[200:203], a[44:47], v[144:147], v[200:203]
    v_mul_f32 v73, v238, v239
    v_mfma_f32_16x16x32_bf16 v[204:207], a[48:51], v[144:147], v[204:207]
    v_lshlrev_b32 v2, 16, v88
    v_mfma_f32_16x16x32_bf16 v[208:211], a[52:55], v[144:147], v[208:211]
    v_lshlrev_b32 v3, 16, v74
    v_mfma_f32_16x16x32_bf16 v[212:215], a[56:59], v[144:147], v[212:215]
    ds_write_b128 v240, v[188:191] offset:8192
    s_waitcnt vmcnt(11)
    v_mfma_f32_16x16x32_bf16 v[196:199], a[60:63], v[148:151], v[196:199]
    v_and_b32 v238, 0xffff0000, v88
    buffer_load_dwordx4 v[128:131], v253, s[60:63], s93 offen offset:3072 sc1
    v_mfma_f32_16x16x32_bf16 v[200:203], a[64:67], v[148:151], v[200:203]
    v_and_b32 v239, 0xffff0000, v74
    v_mfma_f32_16x16x32_bf16 v[204:207], a[68:71], v[148:151], v[204:207]
    v_mul_f32 v88, v2, v3
    v_mfma_f32_16x16x32_bf16 v[208:211], a[72:75], v[148:151], v[208:211]
    ds_write_b128 v240, v[192:195] offset:9216
    v_mul_f32 v74, v238, v239
    v_mfma_f32_16x16x32_bf16 v[212:215], a[76:79], v[148:151], v[212:215]
    s_waitcnt vmcnt(11)
    v_mfma_f32_16x16x32_bf16 v[196:199], a[80:83], v[152:155], v[196:199]
    v_lshlrev_b32 v2, 16, v89
    buffer_load_dwordx4 v[132:135], v254, s[60:63], s93 offen offset:0 sc1
    v_mfma_f32_16x16x32_bf16 v[200:203], a[84:87], v[152:155], v[200:203]
    v_lshlrev_b32_e64 v3, 16, v75
    v_mfma_f32_16x16x32_bf16 v[204:207], a[88:91], v[152:155], v[204:207]
    v_and_b32 v238, 0xffff0000, v89
    v_mfma_f32_16x16x32_bf16 v[208:211], a[92:95], v[152:155], v[208:211]
    v_and_b32 v239, 0xffff0000, v75
    v_mfma_f32_16x16x32_bf16 v[212:215], a[96:99], v[152:155], v[212:215]
    v_mul_f32 v89, v2, v3
    s_waitcnt vmcnt(11)
    v_mfma_f32_16x16x32_bf16 v[196:199], a[100:103], v[156:159], v[196:199]
    buffer_load_dwordx4 v[136:139], v254, s[60:63], s93 offen offset:1024 sc1
    v_mfma_f32_16x16x32_bf16 v[200:203], a[104:107], v[156:159], v[200:203]
    v_mul_f32 v75, v238, v239
    v_mfma_f32_16x16x32_bf16 v[204:207], a[108:111], v[156:159], v[204:207]
    s_waitcnt lgkmcnt(10)
    v_lshlrev_b32 v2, 16, v90
    v_mfma_f32_16x16x32_bf16 v[208:211], a[112:115], v[156:159], v[208:211]
    v_lshlrev_b32 v3, 16, v76
    v_mfma_f32_16x16x32_bf16 v[212:215], a[116:119], v[156:159], v[212:215]
    v_and_b32 v238, 0xffff0000, v90
    s_waitcnt vmcnt(11)
    v_mfma_f32_16x16x32_bf16 v[196:199], a[120:123], v[160:163], v[196:199]
    v_and_b32 v239, 0xffff0000, v76
    buffer_load_dwordx4 v[140:143], v254, s[60:63], s21 offen offset:2048 sc1
    v_mfma_f32_16x16x32_bf16 v[200:203], a[124:127], v[160:163], v[200:203]
    v_mul_f32 v90, v2, v3
    v_mfma_f32_16x16x32_bf16 v[204:207], a[128:131], v[160:163], v[204:207]
    v_mul_f32 v76, v238, v239
    v_mfma_f32_16x16x32_bf16 v[208:211], a[132:135], v[160:163], v[208:211]
    v_lshlrev_b32 v2, 16, v91
    v_mfma_f32_16x16x32_bf16 v[212:215], a[136:139], v[160:163], v[212:215]
    s_waitcnt vmcnt(11)
    v_mfma_f32_16x16x32_bf16 v[196:199], a[140:143], v[164:167], v[196:199]
    v_lshlrev_b32 v3, 16, v77
    buffer_load_dwordx4 v[144:147], v254, s[60:63], s21 offen offset:3072 sc1
    v_mfma_f32_16x16x32_bf16 v[200:203], a[144:147], v[164:167], v[200:203]
    v_and_b32 v238, 0xffff0000, v91
    v_mfma_f32_16x16x32_bf16 v[204:207], a[148:151], v[164:167], v[204:207]
    v_and_b32 v239, 0xffff0000, v77
    v_mfma_f32_16x16x32_bf16 v[208:211], a[152:155], v[164:167], v[208:211]
    v_mul_f32 v91, v2, v3
    v_mfma_f32_16x16x32_bf16 v[212:215], a[156:159], v[164:167], v[212:215]
    v_mul_f32 v77, v238, v239
    s_waitcnt vmcnt(11)
    s_nop 0
    v_mfma_f32_16x16x32_bf16 v[196:199], a[160:163], v[168:171], v[196:199]
    buffer_load_dwordx4 v[148:151], v255, s[60:63], s21 offen offset:0 sc1
    v_mfma_f32_16x16x32_bf16 v[200:203], a[164:167], v[168:171], v[200:203]
    v_mfma_f32_16x16x32_bf16 v[204:207], a[168:171], v[168:171], v[204:207]
    v_mfma_f32_16x16x32_bf16 v[208:211], a[172:175], v[168:171], v[208:211]
    v_mfma_f32_16x16x32_bf16 v[212:215], a[176:179], v[168:171], v[212:215]
    s_waitcnt vmcnt(11)
    s_nop 0
    v_mfma_f32_16x16x32_bf16 v[196:199], a[180:183], v[172:175], v[196:199]
    buffer_load_dwordx4 v[152:155], v255, s[60:63], s21 offen offset:1024 sc1
    v_mfma_f32_16x16x32_bf16 v[200:203], a[184:187], v[172:175], v[200:203]
    v_mfma_f32_16x16x32_bf16 v[204:207], a[188:191], v[172:175], v[204:207]
    v_mfma_f32_16x16x32_bf16 v[208:211], a[192:195], v[172:175], v[208:211]
    v_mfma_f32_16x16x32_bf16 v[212:215], a[196:199], v[172:175], v[212:215]
    s_waitcnt vmcnt(11)
    s_nop 0
    v_mfma_f32_16x16x32_bf16 v[196:199], a[200:203], v[108:111], v[196:199]
    buffer_load_dwordx4 v[156:159], v255, s[60:63], s21 offen offset:2048 sc1
    v_mfma_f32_16x16x32_bf16 v[200:203], a[204:207], v[108:111], v[200:203]
    v_mfma_f32_16x16x32_bf16 v[204:207], a[208:211], v[108:111], v[204:207]
    v_mfma_f32_16x16x32_bf16 v[208:211], a[212:215], v[108:111], v[208:211]
    v_mfma_f32_16x16x32_bf16 v[212:215], a[216:219], v[108:111], v[212:215]
    s_waitcnt vmcnt(11)
    s_nop 0
    v_mfma_f32_16x16x32_bf16 v[196:199], a[220:223], v[112:115], v[196:199]
    buffer_load_dwordx4 v[160:163], v255, s[60:63], s21 offen offset:3072 sc1
    v_mfma_f32_16x16x32_bf16 v[200:203], a[224:227], v[112:115], v[200:203]
    v_mfma_f32_16x16x32_bf16 v[204:207], a[228:231], v[112:115], v[204:207]
    v_mfma_f32_16x16x32_bf16 v[208:211], a[232:235], v[112:115], v[208:211]
    v_mfma_f32_16x16x32_bf16 v[212:215], a[236:239], v[112:115], v[212:215]
    s_waitcnt vmcnt(11)
    s_nop 0
    v_mfma_f32_16x16x32_bf16 v[40:43], a[0:3], v[116:119], v[216:219]
    v_mfma_f32_16x16x32_bf16 v[44:47], a[4:7], v[116:119], v[220:223]
    v_mfma_f32_16x16x32_bf16 v[48:51], a[8:11], v[116:119], v[224:227]
    ds_write_b128 v240, v[196:199] offset:10240
    v_mfma_f32_16x16x32_bf16 v[52:55], a[12:15], v[116:119], v[228:231]
    v_mfma_f32_16x16x32_bf16 v[56:59], a[16:19], v[116:119], v[232:235]
    s_waitcnt vmcnt(10)
    s_nop 0
    v_mfma_f32_16x16x32_bf16 v[40:43], a[20:23], v[120:123], v[40:43]
    buffer_load_dwordx4 v[60:63], v64, s[60:63], 0 offen sc0 sc1
    v_mfma_f32_16x16x32_bf16 v[44:47], a[24:27], v[120:123], v[44:47]
    ds_write_b128 v240, v[200:203] offset:11264
    v_mfma_f32_16x16x32_bf16 v[48:51], a[28:31], v[120:123], v[48:51]
    v_mfma_f32_16x16x32_bf16 v[52:55], a[32:35], v[120:123], v[52:55]
    v_mfma_f32_16x16x32_bf16 v[56:59], a[36:39], v[120:123], v[56:59]
    s_waitcnt vmcnt(10)
    s_nop 0
    v_mfma_f32_16x16x32_bf16 v[40:43], a[40:43], v[124:127], v[40:43]
    ds_write_b128 v240, v[204:207] offset:12288
    v_mfma_f32_16x16x32_bf16 v[44:47], a[44:47], v[124:127], v[44:47]
    v_mfma_f32_16x16x32_bf16 v[48:51], a[48:51], v[124:127], v[48:51]
    v_mfma_f32_16x16x32_bf16 v[52:55], a[52:55], v[124:127], v[52:55]
    v_mfma_f32_16x16x32_bf16 v[56:59], a[56:59], v[124:127], v[56:59]
    ds_write_b128 v240, v[208:211] offset:13312
    s_waitcnt vmcnt(9)
    s_nop 0
    v_mfma_f32_16x16x32_bf16 v[40:43], a[60:63], v[128:131], v[40:43]
    v_mfma_f32_16x16x32_bf16 v[44:47], a[64:67], v[128:131], v[44:47]
    v_mfma_f32_16x16x32_bf16 v[48:51], a[68:71], v[128:131], v[48:51]
    v_mfma_f32_16x16x32_bf16 v[52:55], a[72:75], v[128:131], v[52:55]
    ds_write_b128 v240, v[212:215] offset:14336
    v_mfma_f32_16x16x32_bf16 v[56:59], a[76:79], v[128:131], v[56:59]
    s_waitcnt vmcnt(8)
    s_nop 0
    v_mfma_f32_16x16x32_bf16 v[40:43], a[80:83], v[132:135], v[40:43]
    v_mfma_f32_16x16x32_bf16 v[44:47], a[84:87], v[132:135], v[44:47]
    v_mfma_f32_16x16x32_bf16 v[48:51], a[88:91], v[132:135], v[48:51]
    v_mfma_f32_16x16x32_bf16 v[52:55], a[92:95], v[132:135], v[52:55]
    v_mfma_f32_16x16x32_bf16 v[56:59], a[96:99], v[132:135], v[56:59]
    s_waitcnt vmcnt(7)
    s_nop 0
    v_mfma_f32_16x16x32_bf16 v[40:43], a[100:103], v[136:139], v[40:43]
    v_mfma_f32_16x16x32_bf16 v[44:47], a[104:107], v[136:139], v[44:47]
    v_mfma_f32_16x16x32_bf16 v[48:51], a[108:111], v[136:139], v[48:51]
    v_mfma_f32_16x16x32_bf16 v[52:55], a[112:115], v[136:139], v[52:55]
    v_mfma_f32_16x16x32_bf16 v[56:59], a[116:119], v[136:139], v[56:59]
    s_waitcnt vmcnt(6)
    s_nop 0
    v_mfma_f32_16x16x32_bf16 v[40:43], a[120:123], v[140:143], v[40:43]
    v_mfma_f32_16x16x32_bf16 v[44:47], a[124:127], v[140:143], v[44:47]
    v_mfma_f32_16x16x32_bf16 v[48:51], a[128:131], v[140:143], v[48:51]
    v_mfma_f32_16x16x32_bf16 v[52:55], a[132:135], v[140:143], v[52:55]
    v_mfma_f32_16x16x32_bf16 v[56:59], a[136:139], v[140:143], v[56:59]
    s_waitcnt vmcnt(5)
    s_nop 0
    v_mfma_f32_16x16x32_bf16 v[40:43], a[140:143], v[144:147], v[40:43]
    v_mfma_f32_16x16x32_bf16 v[44:47], a[144:147], v[144:147], v[44:47]
    v_mfma_f32_16x16x32_bf16 v[48:51], a[148:151], v[144:147], v[48:51]
    v_mfma_f32_16x16x32_bf16 v[52:55], a[152:155], v[144:147], v[52:55]
    v_mfma_f32_16x16x32_bf16 v[56:59], a[156:159], v[144:147], v[56:59]
    s_waitcnt vmcnt(4)
    s_nop 0
    v_mfma_f32_16x16x32_bf16 v[40:43], a[160:163], v[148:151], v[40:43]
    v_mfma_f32_16x16x32_bf16 v[44:47], a[164:167], v[148:151], v[44:47]
    v_mfma_f32_16x16x32_bf16 v[48:51], a[168:171], v[148:151], v[48:51]
    v_mfma_f32_16x16x32_bf16 v[52:55], a[172:175], v[148:151], v[52:55]
    v_mfma_f32_16x16x32_bf16 v[56:59], a[176:179], v[148:151], v[56:59]
    s_waitcnt vmcnt(3)
    v_mfma_f32_16x16x32_bf16 v[40:43], a[180:183], v[152:155], v[40:43]
    s_waitcnt vmcnt(0)
    v_xor_b32 v60, s10, v60
    v_xor_b32 v61, s10, v61
    v_xor_b32 v62, s10, v62
    v_xor_b32 v63, s10, v63
    v_or_b32 v60, v60, v61
    v_or_b32 v60, v60, v62
    v_or_b32 v60, v60, v63
    v_cmp_ne_u32 vcc, 0, v60
    s_nop 0
    s_cbranch_vccnz .Lc7s
.Lc7b:
    s_mul_i32 s11, s3, 2560
    s_add_u32 s11, s11, 126976
    s_add_u32 m0, s11, 0
    s_nop 0
    buffer_load_dwordx4 v251, s[60:63], s94 offen sc1 lds
    s_add_u32 m0, s11, 1024
    s_nop 0
    buffer_load_dwordx4 v251, s[60:63], s95 offen sc1 lds
    s_add_u32 m0, s11, 1536
    s_nop 0
    buffer_load_dwordx4 v251, s[60:63], s96 offen sc1 lds
    v_mfma_f32_16x16x32_bf16 v[44:47], a[184:187], v[152:155], v[44:47]
    v_mfma_f32_16x16x32_bf16 v[48:51], a[188:191], v[152:155], v[48:51]
    v_mfma_f32_16x16x32_bf16 v[52:55], a[192:195], v[152:155], v[52:55]
    v_mfma_f32_16x16x32_bf16 v[56:59], a[196:199], v[152:155], v[56:59]
    v_mfma_f32_16x16x32_bf16 v[40:43], a[200:203], v[156:159], v[40:43]
    v_mfma_f32_16x16x32_bf16 v[44:47], a[204:207], v[156:159], v[44:47]
    v_mfma_f32_16x16x32_bf16 v[48:51], a[208:211], v[156:159], v[48:51]
    v_mfma_f32_16x16x32_bf16 v[52:55], a[212:215], v[156:159], v[52:55]
    v_mfma_f32_16x16x32_bf16 v[56:59], a[216:219], v[156:159], v[56:59]
    v_mfma_f32_16x16x32_bf16 v[40:43], a[220:223], v[160:163], v[40:43]
    v_mfma_f32_16x16x32_bf16 v[44:47], a[224:227], v[160:163], v[44:47]
    v_mfma_f32_16x16x32_bf16 v[48:51], a[228:231], v[160:163], v[48:51]
    v_mfma_f32_16x16x32_bf16 v[52:55], a[232:235], v[160:163], v[52:55]
    v_mfma_f32_16x16x32_bf16 v[56:59], a[236:239], v[160:163], v[56:59]
    s_waitcnt lgkmcnt(0)
    s_barrier
    ds_read_b128 v[108:111], v66 offset:0
    ds_read_b128 v[112:115], v66 offset:1024
    ds_read_b128 v[116:119], v66 offset:2048
    ds_read_b128 v[120:123], v66 offset:3072
    ds_read_b128 v[124:127], v66 offset:4096
    ds_read_b128 v[128:131], v67 offset:5120
    ds_read_b128 v[132:135], v67 offset:6144
    ds_read_b128 v[136:139], v67 offset:7168
    ds_read_b128 v[140:143], v67 offset:8192
    ds_read_b128 v[144:147], v67 offset:9216
    ds_read_b128 v[148:151], v1 offset:10240
    ds_read_b128 v[152:155], v1 offset:11264
    ds_read_b128 v[156:159], v1 offset:12288
    ds_read_b128 v[160:163], v1 offset:13312
    ds_read_b128 v[164:167], v1 offset:14336
    s_waitcnt lgkmcnt(14)
    v_pk_add_f32 v[40:41], v[40:41], v[108:109]
    v_pk_add_f32 v[42:43], v[42:43], v[110:111]
    s_waitcnt lgkmcnt(13)
    v_pk_add_f32 v[44:45], v[44:45], v[112:113]
    v_pk_add_f32 v[46:47], v[46:47], v[114:115]
    s_waitcnt lgkmcnt(12)
    v_pk_add_f32 v[48:49], v[48:49], v[116:117]
    v_pk_add_f32 v[50:51], v[50:51], v[118:119]
    s_waitcnt lgkmcnt(11)
    v_pk_add_f32 v[52:53], v[52:53], v[120:121]
    v_pk_add_f32 v[54:55], v[54:55], v[122:123]
    s_waitcnt lgkmcnt(10)
    v_pk_add_f32 v[56:57], v[56:57], v[124:125]
    v_pk_add_f32 v[58:59], v[58:59], v[126:127]
    s_waitcnt lgkmcnt(9)
    v_pk_add_f32 v[40:41], v[40:41], v[128:129]
    v_pk_add_f32 v[42:43], v[42:43], v[130:131]
    s_waitcnt lgkmcnt(8)
    v_pk_add_f32 v[44:45], v[44:45], v[132:133]
    v_pk_add_f32 v[46:47], v[46:47], v[134:135]
    s_waitcnt lgkmcnt(7)
    v_pk_add_f32 v[48:49], v[48:49], v[136:137]
    v_pk_add_f32 v[50:51], v[50:51], v[138:139]
    s_waitcnt lgkmcnt(6)
    v_pk_add_f32 v[52:53], v[52:53], v[140:141]
    v_pk_add_f32 v[54:55], v[54:55], v[142:143]
    s_waitcnt lgkmcnt(5)
    v_pk_add_f32 v[56:57], v[56:57], v[144:145]
    v_pk_add_f32 v[58:59], v[58:59], v[146:147]
    s_waitcnt lgkmcnt(4)
    v_pk_add_f32 v[40:41], v[40:41], v[148:149]
    v_pk_add_f32 v[42:43], v[42:43], v[150:151]
    s_waitcnt lgkmcnt(3)
    v_pk_add_f32 v[44:45], v[44:45], v[152:153]
    v_pk_add_f32 v[46:47], v[46:47], v[154:155]
    s_waitcnt lgkmcnt(2)
    v_pk_add_f32 v[48:49], v[48:49], v[156:157]
    v_pk_add_f32 v[50:51], v[50:51], v[158:159]
    s_waitcnt lgkmcnt(1)
    v_pk_add_f32 v[52:53], v[52:53], v[160:161]
    v_pk_add_f32 v[54:55], v[54:55], v[162:163]
    s_waitcnt lgkmcnt(0)
    s_nop 0
    v_pk_add_f32 v[56:57], v[56:57], v[164:165]
    v_pk_add_f32 v[58:59], v[58:59], v[166:167]
    v_pk_mul_f32 v[108:109], v[40:41], s[12:13]
    v_pk_mul_f32 v[110:111], v[42:43], s[12:13]
    v_pk_mul_f32 v[112:113], v[44:45], s[12:13]
    v_pk_mul_f32 v[114:115], v[46:47], s[12:13]
    v_pk_mul_f32 v[116:117], v[48:49], s[12:13]
    v_pk_mul_f32 v[118:119], v[50:51], s[12:13]
    v_pk_mul_f32 v[120:121], v[52:53], s[12:13]
    v_pk_mul_f32 v[122:123], v[54:55], s[12:13]
    v_pk_mul_f32 v[124:125], v[56:57], s[12:13]
    v_pk_mul_f32 v[126:127], v[58:59], s[12:13]
    v_exp_f32 v108, v108
    v_exp_f32 v109, v109
    v_exp_f32 v110, v110
    v_exp_f32 v111, v111
    v_exp_f32 v112, v112
    v_exp_f32 v113, v113
    v_exp_f32 v114, v114
    v_exp_f32 v115, v115
    v_exp_f32 v116, v116
    v_exp_f32 v117, v117
    v_exp_f32 v118, v118
    v_exp_f32 v119, v119
    v_exp_f32 v120, v120
    v_exp_f32 v121, v121
    v_exp_f32 v122, v122
    v_exp_f32 v123, v123
    v_exp_f32 v124, v124
    v_exp_f32 v125, v125
    v_exp_f32 v126, v126
    v_exp_f32 v127, v127
    v_pk_add_f32 v[108:109], v[108:109], s[14:15]
    v_pk_add_f32 v[110:111], v[110:111], s[14:15]
    v_pk_add_f32 v[112:113], v[112:113], s[14:15]
    v_pk_add_f32 v[114:115], v[114:115], s[14:15]
    v_pk_add_f32 v[116:117], v[116:117], s[14:15]
    v_pk_add_f32 v[118:119], v[118:119], s[14:15]
    v_pk_add_f32 v[120:121], v[120:121], s[14:15]
    v_pk_add_f32 v[122:123], v[122:123], s[14:15]
    v_pk_add_f32 v[124:125], v[124:125], s[14:15]
    v_pk_add_f32 v[126:127], v[126:127], s[14:15]
    v_rcp_f32 v108, v108
    v_rcp_f32 v109, v109
    v_rcp_f32 v110, v110
    v_rcp_f32 v111, v111
    v_rcp_f32 v112, v112
    v_rcp_f32 v113, v113
    v_rcp_f32 v114, v114
    v_rcp_f32 v115, v115
    v_rcp_f32 v116, v116
    v_rcp_f32 v117, v117
    v_rcp_f32 v118, v118
    v_rcp_f32 v119, v119
    v_rcp_f32 v120, v120
    v_rcp_f32 v121, v121
    v_rcp_f32 v122, v122
    v_rcp_f32 v123, v123
    v_rcp_f32 v124, v124
    v_rcp_f32 v125, v125
    v_rcp_f32 v126, v126
    v_rcp_f32 v127, v127
    s_waitcnt vmcnt(0)
    s_barrier
    ds_read_b64_tr_b16 v[196:197], v65 offset:0
    ds_read_b64_tr_b16 v[198:199], v65 offset:2048
    ds_read_b64_tr_b16 v[200:201], v65 offset:4096
    ds_read_b64_tr_b16 v[202:203], v65 offset:6144
    ds_read_b64_tr_b16 v[204:205], v65 offset:8192
    v_pk_mul_f32 v[40:41], v[40:41], v[108:109]
    v_pk_mul_f32 v[42:43], v[42:43], v[110:111]
    v_pk_mul_f32 v[44:45], v[44:45], v[112:113]
    v_pk_mul_f32 v[46:47], v[46:47], v[114:115]
    v_pk_mul_f32 v[48:49], v[48:49], v[116:117]
    v_pk_mul_f32 v[50:51], v[50:51], v[118:119]
    v_pk_mul_f32 v[52:53], v[52:53], v[120:121]
    v_pk_mul_f32 v[54:55], v[54:55], v[122:123]
    v_pk_mul_f32 v[56:57], v[56:57], v[124:125]
    v_pk_mul_f32 v[58:59], v[58:59], v[126:127]
    s_waitcnt lgkmcnt(4)
    v_dot2_f32_bf16 v176, v196, s72, v14
    v_dot2_f32_bf16 v177, v196, s73, v68
    v_dot2_f32_bf16 v178, v197, s72, v15
    v_dot2_f32_bf16 v179, v197, s73, v69
    s_waitcnt lgkmcnt(3)
    v_dot2_f32_bf16 v180, v198, s72, v16
    v_dot2_f32_bf16 v181, v198, s73, v70
    v_dot2_f32_bf16 v182, v199, s72, v17
    v_dot2_f32_bf16 v183, v199, s73, v71
    s_waitcnt lgkmcnt(2)
    v_dot2_f32_bf16 v184, v200, s72, v18
    v_dot2_f32_bf16 v185, v200, s73, v72
    v_dot2_f32_bf16 v186, v201, s72, v19
    v_dot2_f32_bf16 v187, v201, s73, v73
    s_waitcnt lgkmcnt(1)
    v_dot2_f32_bf16 v188, v202, s72, v88
    v_dot2_f32_bf16 v189, v202, s73, v74
    v_dot2_f32_bf16 v190, v203, s72, v89
    v_dot2_f32_bf16 v191, v203, s73, v75
    s_waitcnt lgkmcnt(0)
    s_nop 0
    v_dot2_f32_bf16 v192, v204, s72, v90
    v_dot2_f32_bf16 v193, v204, s73, v76
    v_dot2_f32_bf16 v194, v205, s72, v91
    v_dot2_f32_bf16 v195, v205, s73, v77
    v_pk_fma_f32 v[40:41], v[40:41], v[176:177], v[92:93]
    v_pk_fma_f32 v[42:43], v[42:43], v[178:179], v[100:101]
    v_pk_fma_f32 v[44:45], v[44:45], v[180:181], v[102:103]
    v_pk_fma_f32 v[46:47], v[46:47], v[182:183], v[244:245]
    v_pk_fma_f32 v[48:49], v[48:49], v[184:185], v[246:247]
    v_pk_fma_f32 v[50:51], v[50:51], v[186:187], v[78:79]
    v_pk_fma_f32 v[52:53], v[52:53], v[188:189], v[80:81]
    v_pk_fma_f32 v[54:55], v[54:55], v[190:191], v[82:83]
    v_pk_fma_f32 v[56:57], v[56:57], v[192:193], v[84:85]
    v_pk_fma_f32 v[58:59], v[58:59], v[194:195], v[86:87]
    v_cvt_pk_bf16_f32 v4, v40, v41
    v_cvt_pk_bf16_f32 v5, v42, v43
    v_cvt_pk_bf16_f32 v6, v44, v45
    v_cvt_pk_bf16_f32 v7, v46, v47
    v_cvt_pk_bf16_f32 v8, v48, v49
    v_cvt_pk_bf16_f32 v9, v50, v51
    v_cvt_pk_bf16_f32 v10, v52, v53
    v_cvt_pk_bf16_f32 v11, v54, v55
    v_cvt_pk_bf16_f32 v12, v56, v57
    v_cvt_pk_bf16_f32 v13, v58, v59
    ds_write_b64 v98, v[4:5] offset:0
    ds_write_b64 v98, v[6:7] offset:32
    ds_write_b64 v98, v[8:9] offset:64
    ds_write_b64 v98, v[10:11] offset:96
    ds_write_b64 v98, v[12:13] offset:128
    ds_read_b128 v[128:131], v104 offset:0
    ds_read_b128 v[132:135], v104 offset:1024
    ds_read_b128 v[136:139], v104 offset:2048
    s_waitcnt lgkmcnt(2)
    buffer_store_dwordx4 v[128:131], v95, s[64:67], s87 offen
    s_waitcnt lgkmcnt(1)
    buffer_store_dwordx4 v[132:135], v96, s[64:67], s87 offen
    s_mov_b32 exec_hi, 0
    s_waitcnt lgkmcnt(0)
    buffer_store_dwordx4 v[136:139], v97, s[64:67], s87 offen
    s_mov_b32 exec_hi, -1
.Lend:
    s_endpgm
.Lnonce_s:
    s_mov_b32 s11, 0
.Lnonce_l:
    global_load_dword v15, v3, s[42:43] sc0 sc1
    s_waitcnt vmcnt(0)
    v_readfirstlane_b32 s10, v15
    s_add_u32 s11, s11, 1
    s_cmp_gt_u32 s11, 2000000
    s_cbranch_scc1 .Lnonce_b
    s_cmp_eq_u32 s10, 0
    s_cbranch_scc1 .Lnonce_l
    s_branch .Lnonce_b
.Lws:
    s_mov_b32 s70, 0
.Lwl:
    buffer_load_dword v1, v240, s[60:63], 0 offen sc0 sc1
    global_load_dword v2, v3, s[42:43] sc0 sc1
    s_waitcnt vmcnt(0)
    v_readfirstlane_b32 s10, v2
    s_nop 1
    v_xor_b32 v1, s10, v1
    v_cmp_eq_u32 vcc, 0, v2
    s_nop 1
    v_cndmask_b32 v1, v1, 1, vcc
    v_cmp_ne_u32 vcc, 0, v1
    s_add_u32 s70, s70, 1
    s_cmp_gt_u32 s70, 2000000
    s_cbranch_scc1 .Lwx
    s_cbranch_vccz .Lwx
    s_sleep 4
    s_branch .Lwl
.Lwx:
    s_add_u32 s77, s80, 0
    s_and_b32 s77, s77, 7
    s_mul_i32 s77, s77, 5120
    s_add_u32 s77, s77, s76
    buffer_load_dwordx4 a[120:123], v253, s[60:63], s77 offen offset:0 sc1
    buffer_load_dwordx4 a[124:127], v253, s[60:63], s77 offen offset:1024 sc1
    buffer_load_dwordx4 a[128:131], v253, s[60:63], s77 offen offset:2048 sc1
    buffer_load_dwordx4 a[132:135], v253, s[60:63], s77 offen offset:3072 sc1
    buffer_load_dwordx4 a[136:139], v252, s[60:63], s77 offen offset:3072 sc1
    s_add_u32 s77, s80, 1
    s_and_b32 s77, s77, 7
    s_mul_i32 s77, s77, 5120
    s_add_u32 s77, s77, s76
    buffer_load_dwordx4 a[140:143], v253, s[60:63], s77 offen offset:0 sc1
    buffer_load_dwordx4 a[144:147], v253, s[60:63], s77 offen offset:1024 sc1
    buffer_load_dwordx4 a[148:151], v253, s[60:63], s77 offen offset:2048 sc1
    s_nop 4
    s_branch .Lwb
.Lxs:
    s_mov_b32 s70, 0
.Lxl:
    buffer_load_dword v1, v240, s[60:63], 0 offen sc0 sc1
    global_load_dword v2, v3, s[42:43] sc0 sc1
    s_waitcnt vmcnt(0)
    v_readfirstlane_b32 s10, v2
    s_nop 1
    v_xor_b32 v1, s10, v1
    v_cmp_eq_u32 vcc, 0, v2
    s_nop 1
    v_cndmask_b32 v1, v1, 1, vcc
    v_cmp_ne_u32 vcc, 0, v1
    s_add_u32 s70, s70, 1
    s_cmp_gt_u32 s70, 2000000
    s_cbranch_scc1 .Lxx
    s_cbranch_vccz .Lxx
    s_sleep 4
    s_branch .Lxl
.Lxx:
    s_add_u32 s77, s80, 0
    s_and_b32 s77, s77, 7
    s_mul_i32 s77, s77, 5120
    s_add_u32 s77, s77, s76
    s_nop 0
    buffer_load_dwordx4 a[120:123], v253, s[60:63], s77 offen offset:0 sc1
    buffer_load_dwordx4 a[124:127], v253, s[60:63], s77 offen offset:1024 sc1
    buffer_load_dwordx4 a[128:131], v253, s[60:63], s77 offen offset:2048 sc1
    buffer_load_dwordx4 a[132:135], v253, s[60:63], s77 offen offset:3072 sc1
    buffer_load_dwordx4 a[136:139], v252, s[60:63], s77 offen offset:3072 sc1
    s_add_u32 s77, s80, 1
    s_and_b32 s77, s77, 7
    s_mul_i32 s77, s77, 5120
    s_add_u32 s77, s77, s76
    buffer_load_dwordx4 a[140:143], v253, s[60:63], s77 offen offset:0 sc1
    buffer_load_dwordx4 a[144:147], v253, s[60:63], s77 offen offset:1024 sc1
    buffer_load_dwordx4 a[148:151], v253, s[60:63], s77 offen offset:2048 sc1
    s_nop 4
    s_branch .Lxb
.Lc6s:
    s_mov_b32 s70, 0
.Lc6l:
    buffer_load_dwordx4 v[156:159], v249, s[60:63], 0 offen sc0 sc1
    s_waitcnt vmcnt(0)
    v_xor_b32 v156, s10, v156
    v_xor_b32 v157, s10, v157
    v_xor_b32 v158, s10, v158
    v_xor_b32 v159, s10, v159
    v_or_b32 v156, v156, v157
    v_or_b32 v156, v156, v158
    v_or_b32 v156, v156, v159
    v_cmp_ne_u32 vcc, 0, v156
    s_add_u32 s70, s70, 1
    s_cmp_gt_u32 s70, 2000000
    s_cbranch_scc1 .Lc6x
    s_cbranch_vccz .Lc6x
    s_sleep 4
    s_branch .Lc6l
.Lc6x:
    s_nop 4
    s_branch .Lc6b
.Lhs:
    s_mov_b32 s70, 0
.Lhl:
    buffer_load_dword v62, v250, s[60:63], 0 offen sc0 sc1
    s_waitcnt vmcnt(0)
    v_xor_b32 v62, s10, v62
    v_cmp_ne_u32 vcc, 0, v62
    s_add_u32 s70, s70, 1
    s_cmp_gt_u32 s70, 2000000
    s_cbranch_scc1 .Lhx
    s_cbranch_vccz .Lhx
    s_sleep 4
    s_branch .Lhl
.Lhx:
    buffer_load_dwordx4 v[108:111], v253, s[60:63], s90 offen offset:0 sc1
    s_nop 4
    s_branch .Lhb
.Lc7s:
    s_mov_b32 s70, 0
.Lc7l:
    buffer_load_dwordx4 v[60:63], v64, s[60:63], 0 offen sc0 sc1
    s_waitcnt vmcnt(0)
    v_xor_b32 v60, s10, v60
    v_xor_b32 v61, s10, v61
    v_xor_b32 v62, s10, v62
    v_xor_b32 v63, s10, v63
    v_or_b32 v60, v60, v61
    v_or_b32 v60, v60, v62
    v_or_b32 v60, v60, v63
    v_cmp_ne_u32 vcc, 0, v60
    s_add_u32 s70, s70, 1
    s_cmp_gt_u32 s70, 2000000
    s_cbranch_scc1 .Lc7x
    s_cbranch_vccz .Lc7x
    s_sleep 4
    s_branch .Lc7l
.Lc7x:
    s_nop 4
    s_branch .Lc7b
    s_endpgm
.fill (38144 - (. - recurrent_scan__ssm_conv_s4d__dense_activation_squared_relu__prompt_kernel)) / 4, 4, 0xbf800000
.section .rodata,"a"
.p2align 6
.amdhsa_kernel recurrent_scan__ssm_conv_s4d__dense_activation_squared_relu__prompt_kernel
  .amdhsa_next_free_vgpr 512
  .amdhsa_next_free_sgpr 102
  .amdhsa_accum_offset 256
  .amdhsa_group_segment_fixed_size 0
  .amdhsa_kernarg_size 120
  .amdhsa_user_sgpr_count 2
  .amdhsa_user_sgpr_kernarg_segment_ptr 1
  .amdhsa_system_sgpr_workgroup_id_x 1
.end_amdhsa_kernel
```
